```python
import torch

def _softmax(x, axis=-1):
    return torch.softmax(x, dim=axis)

def _gelu(x):
    return torch.nn.functional.gelu(x, approximate='tanh')

def _silu(x):
    return torch.nn.functional.silu(x)

def _sigmoid(x):
    return torch.sigmoid(x)

def _layernorm(x, axis=-1, eps=1e-05):
    m = x.mean(dim=axis, keepdim=True)
    v = x.var(dim=axis, keepdim=True, unbiased=False)
    return (x - m) / torch.sqrt(v + eps)

def _scatter_add(tgt, idx, src, axis=0):
    return tgt.clone().index_add_(axis, idx, src)

def _segment_sum(src, seg, n):
    out = torch.zeros((n,) + src.shape[1:], dtype=src.dtype)
    return out.index_add_(0, seg, src)

def _pad(x, pw):
    flat = tuple((v for pair in reversed(pw) for v in pair))
    return torch.nn.functional.pad(x, flat)
kernel_name = 'sequential_preLN__memory_aug_recurrent_mem_tr__glu_gated_reglu__prompt'

def setup_inputs():

    _w = lambda a: (lambda t: t.to(torch.bfloat16) if t.is_floating_point() else t)(torch.as_tensor(a))

    def _A_setup():
        B, S, Dm = (1, 2048, 448)
        H, Dh = (16, 256)
        M, seg = (8, 32)
        seg = min(seg, S)
        S = S // seg * seg
        return {'x': _w((lambda *s: torch.randn(*s, dtype=torch.bfloat16) * 0.05)(B, S, Dm)), 'mem0': _w((lambda *s: torch.randn(*s, dtype=torch.bfloat16) * 0.2)(B, M, Dm)), 'Wq': _w((lambda *s: torch.randn(*s, dtype=torch.bfloat16) * 1.6)(Dm, H, Dh) * Dm ** (-0.5)), 'Wk': _w((lambda *s: torch.randn(*s, dtype=torch.bfloat16) * 1.6)(Dm, H, Dh) * Dm ** (-0.5)), 'Wv': _w((lambda *s: torch.randn(*s, dtype=torch.bfloat16) * 0.2)(Dm, H, Dh) * Dm ** (-0.5)), 'Wo': _w((lambda *s: torch.randn(*s, dtype=torch.bfloat16) * 0.2)(H, Dh, Dm) * (H * Dh) ** (-0.5)), 'seg_len': seg}
    _A_in = _A_setup()

    def _B_setup():
        B, S, D, F = (1, 2048, 448, 1792)
        return {'x': _w((lambda *s: torch.randn(*s, dtype=torch.bfloat16) * 0.05)(B, S, D)), 'W_gate': _w((lambda *s: torch.randn(*s, dtype=torch.bfloat16) * 0.2)(D, F) * (2.0 / D) ** 0.5), 'W_up': _w((lambda *s: torch.randn(*s, dtype=torch.bfloat16) * 0.2)(D, F) * (2.0 / D) ** 0.5), 'W_down': _w((lambda *s: torch.randn(*s, dtype=torch.bfloat16) * 0.2)(F, D) * (1.0 / F) ** 0.5)}
    _B_in = _B_setup()
    return {'A_x': _A_in['x'], 'A_mem0': _A_in['mem0'], 'A_Wq': _A_in['Wq'], 'A_Wk': _A_in['Wk'], 'A_Wv': _A_in['Wv'], 'A_Wo': _A_in['Wo'], 'A_seg_len': _A_in['seg_len'], 'B_x': _B_in['x'], 'B_W_gate': _B_in['W_gate'], 'B_W_up': _B_in['W_up'], 'B_W_down': _B_in['W_down']}

def reference(A_x, A_mem0, A_Wq, A_Wk, A_Wv, A_Wo, A_seg_len, B_x, B_W_gate, B_W_up, B_W_down):

    def _A_ref(x, mem0, Wq, Wk, Wv, Wo, seg_len):
        B, S, Dm = x.shape
        H, Dh = (Wq.shape[1], Wq.shape[2])
        M = mem0.shape[1]
        scale = Dh ** (-0.5)
        n_seg = S // seg_len
        L = M + seg_len
        idx = torch.arange(L)
        mask = (idx[:, None] < M) | (idx[:, None] >= idx[None, :])
        mem = mem0
        outs = []
        for s in range(n_seg):
            xs = x[:, s * seg_len:(s + 1) * seg_len, :].clone()
            h = torch.concatenate([mem, xs], axis=1)
            q = torch.einsum('btd,dhe->bhte', h, Wq)
            k = torch.einsum('btd,dhe->bhte', h, Wk)
            v = torch.einsum('btd,dhe->bhte', h, Wv)
            scores = torch.einsum('bhqe,bhke->bhqk', q, k) * scale
            scores = torch.where(mask[None, None], scores, -1000000000.0)
            p = _softmax(scores, axis=-1)
            o = torch.einsum('bhqk,bhke->bhqe', p, v)
            o = torch.einsum('bhte,hed->btd', o, Wo)
            mem = o[:, :M, :].clone()
            outs.append(o[:, M:, :])
        return torch.concatenate(outs, axis=1)

    def _B_ref(x, W_gate, W_up, W_down):
        gate = torch.einsum('bsd,df->bsf', x, W_gate)
        up = torch.einsum('bsd,df->bsf', x, W_up)
        gate = gate * (lambda x, dt: x.to(dt))(gate > 0, gate.dtype)
        h = gate * up
        return torch.einsum('bsf,fd->bsd', h, W_down)
    x = A_x
    h = x + _A_ref(_layernorm(x, axis=-1), A_mem0, A_Wq, A_Wk, A_Wv, A_Wo, A_seg_len)
    h2 = h + _B_ref(_layernorm(h, axis=-1), B_W_gate, B_W_up, B_W_down)
    return h2
```

```asm
; @launch kernel=prep_kernel grid=(3254,1,1) block=(256,1,1) lds=40960
; @launch kernel=main_kernel grid=(256,1,1) block=(256,1,1) lds=81920
.amdgcn_target "amdgcn-amd-amdhsa--gfx950"
.text
.p2align 8
.type prep_kernel,@function
prep_kernel:
    s_load_dwordx2 s[6:7], s[0:1], 104
    v_lshrrev_b32 v1, 6, v0
    v_and_b32 v2, 63, v0
    s_nop 0
    v_readfirstlane_b32 s20, v1
    s_cmp_lt_u32 s2, 512
    s_cbranch_scc1 P_LN
    s_cmp_lt_u32 s2, 1296
    s_cbranch_scc1 P_QK
    s_cmp_lt_u32 s2, 2864
    s_cbranch_scc1 P_VO
    s_cmp_lt_u32 s2, 3158
    s_cbranch_scc1 P_REP
    s_cmp_lt_u32 s2, 3254
    s_cbranch_scc1 P_INIT
    s_endpgm
P_LN:
    s_load_dwordx2 s[4:5], s[0:1], 0
    s_waitcnt lgkmcnt(0)
    s_mov_b32 s8, s4
    s_mov_b32 s9, s5
    s_mov_b32 s10, 1835008
    s_mov_b32 s11, 0x00020000
    s_mov_b32 s12, s6
    s_mov_b32 s13, s7
    s_mov_b32 s14, 268435456
    s_mov_b32 s15, 0x00020000
    s_sub_u32 s3, s2, 0
    s_lshl_b32 s3, s3, 2
    v_add_u32 v3, s3, v1
    v_mul_u32_u24 v4, 0x380, v3
    v_lshl_add_u32 v4, v2, 4, v4
    v_mov_b32 v8, 0
    v_mov_b32 v9, 0
    v_mov_b32 v10, 0
    v_mov_b32 v11, 0
    v_mov_b32 v24, 0
    v_mov_b32 v25, 0
    v_cmp_gt_u32 vcc, 56, v2
    s_and_saveexec_b64 s[16:17], vcc
    buffer_load_dwordx4 v[8:11], v4, s[8:11], 0 offen
    s_waitcnt vmcnt(0)
    v_lshlrev_b32 v16, 16, v8
    v_and_b32 v17, 0xffff0000, v8
    v_lshlrev_b32 v18, 16, v9
    v_and_b32 v19, 0xffff0000, v9
    v_lshlrev_b32 v20, 16, v10
    v_and_b32 v21, 0xffff0000, v10
    v_lshlrev_b32 v22, 16, v11
    v_and_b32 v23, 0xffff0000, v11
    v_add_f32 v24, v16, v17
    v_add_f32 v24, v24, v18
    v_add_f32 v24, v24, v19
    v_add_f32 v24, v24, v20
    v_add_f32 v24, v24, v21
    v_add_f32 v24, v24, v22
    v_add_f32 v24, v24, v23
    s_mov_b64 exec, s[16:17]
    s_nop 1
    v_add_f32_dpp v24, v24, v24 quad_perm:[1,0,3,2] row_mask:0xf bank_mask:0xf
    s_nop 1
    v_add_f32_dpp v24, v24, v24 quad_perm:[2,3,0,1] row_mask:0xf bank_mask:0xf
    s_nop 1
    v_add_f32_dpp v24, v24, v24 row_half_mirror row_mask:0xf bank_mask:0xf
    s_nop 1
    v_add_f32_dpp v24, v24, v24 row_mirror row_mask:0xf bank_mask:0xf
    v_mov_b32 v26, v24
    s_nop 1
    v_permlane16_swap_b32 v26, v24
    s_nop 1
    v_add_f32 v24, v24, v26
    v_mov_b32 v26, v24
    s_nop 1
    v_permlane32_swap_b32 v26, v24
    s_nop 1
    v_add_f32 v24, v24, v26
    v_mul_f32 v24, 0.002232142857142857, v24
    s_and_b64 exec, exec, vcc
    v_sub_f32 v27, v16, v24
    v_fmac_f32 v25, v27, v27
    v_sub_f32 v27, v17, v24
    v_fmac_f32 v25, v27, v27
    v_sub_f32 v27, v18, v24
    v_fmac_f32 v25, v27, v27
    v_sub_f32 v27, v19, v24
    v_fmac_f32 v25, v27, v27
    v_sub_f32 v27, v20, v24
    v_fmac_f32 v25, v27, v27
    v_sub_f32 v27, v21, v24
    v_fmac_f32 v25, v27, v27
    v_sub_f32 v27, v22, v24
    v_fmac_f32 v25, v27, v27
    v_sub_f32 v27, v23, v24
    v_fmac_f32 v25, v27, v27
    s_mov_b64 exec, s[16:17]
    s_nop 1
    v_add_f32_dpp v25, v25, v25 quad_perm:[1,0,3,2] row_mask:0xf bank_mask:0xf
    s_nop 1
    v_add_f32_dpp v25, v25, v25 quad_perm:[2,3,0,1] row_mask:0xf bank_mask:0xf
    s_nop 1
    v_add_f32_dpp v25, v25, v25 row_half_mirror row_mask:0xf bank_mask:0xf
    s_nop 1
    v_add_f32_dpp v25, v25, v25 row_mirror row_mask:0xf bank_mask:0xf
    v_mov_b32 v26, v25
    s_nop 1
    v_permlane16_swap_b32 v26, v25
    s_nop 1
    v_add_f32 v25, v25, v26
    v_mov_b32 v26, v25
    s_nop 1
    v_permlane32_swap_b32 v26, v25
    s_nop 1
    v_add_f32 v25, v25, v26
    v_mul_f32 v25, 0.002232142857142857, v25
    v_cvt_pk_bf16_f32 v24, v24, v25
    v_and_b32 v25, 0xffff0000, v24
    v_lshlrev_b32 v24, 16, v24
    v_add_f32 v25, 0x3727c5ac, v25
    v_cvt_pk_bf16_f32 v25, v25, v25
    v_lshlrev_b32 v25, 16, v25
    v_sqrt_f32 v25, v25
    s_nop 0
    v_cvt_pk_bf16_f32 v25, v25, v25
    v_lshlrev_b32 v25, 16, v25
    v_rcp_f32 v25, v25
    v_sub_f32 v16, v16, v24
    v_sub_f32 v17, v17, v24
    v_sub_f32 v18, v18, v24
    v_sub_f32 v19, v19, v24
    v_sub_f32 v20, v20, v24
    v_sub_f32 v21, v21, v24
    v_sub_f32 v22, v22, v24
    v_sub_f32 v23, v23, v24
    v_cvt_pk_bf16_f32 v8, v16, v17
    v_cvt_pk_bf16_f32 v9, v18, v19
    v_cvt_pk_bf16_f32 v10, v20, v21
    v_cvt_pk_bf16_f32 v11, v22, v23
    v_lshlrev_b32 v16, 16, v8
    v_and_b32 v17, 0xffff0000, v8
    v_lshlrev_b32 v18, 16, v9
    v_and_b32 v19, 0xffff0000, v9
    v_lshlrev_b32 v20, 16, v10
    v_and_b32 v21, 0xffff0000, v10
    v_lshlrev_b32 v22, 16, v11
    v_and_b32 v23, 0xffff0000, v11
    v_mul_f32 v16, v16, v25
    v_mul_f32 v17, v17, v25
    v_mul_f32 v18, v18, v25
    v_mul_f32 v19, v19, v25
    v_mul_f32 v20, v20, v25
    v_mul_f32 v21, v21, v25
    v_mul_f32 v22, v22, v25
    v_mul_f32 v23, v23, v25
    v_cvt_pk_bf16_f32 v8, v16, v17
    v_cvt_pk_bf16_f32 v9, v18, v19
    v_cvt_pk_bf16_f32 v10, v20, v21
    v_cvt_pk_bf16_f32 v11, v22, v23
    v_lshrrev_b32 v5, 5, v3
    v_mul_u32_u24 v5, 28672, v5
    v_lshrrev_b32 v6, 2, v2
    v_lshl_add_u32 v5, v6, 11, v5
    v_bfe_u32 v6, v3, 4, 1
    v_lshl_add_u32 v5, v6, 10, v5
    v_and_b32 v6, 3, v2
    v_lshl_add_u32 v5, v6, 8, v5
    v_and_b32 v6, 15, v3
    v_lshl_add_u32 v5, v6, 4, v5
    s_and_b64 exec, exec, vcc
    buffer_store_dwordx4 v[8:11], v5, s[12:15], 0 offen offset:0
    s_endpgm
P_QK:
    s_load_dwordx2 s[4:5], s[0:1], 16
    s_load_dwordx2 s[18:19], s[0:1], 24
    s_sub_u32 s3, s2, 512
    v_and_b32 v3, 15, v2
    v_lshrrev_b32 v4, 4, v2
    v_lshlrev_b32 v5, 13, v3
    v_lshl_add_u32 v5, v4, 4, v5
    v_lshlrev_b32 v11, 4, v2
    s_and_b32 s36, s3, 7
    s_lshr_b32 s37, s3, 3
    s_mul_i32 s3, s36, 98
    s_add_u32 s3, s3, s37
    s_mul_i32 s38, s3, 149797
    s_lshr_b32 s38, s38, 20
    s_mul_i32 s39, s38, 7
    s_sub_u32 s39, s3, s39
    s_mul_i32 s21, s38, 9363
    s_lshr_b32 s21, s21, 16
    s_mul_i32 s22, s21, 7
    s_sub_u32 s40, s38, s22
    s_lshl_b32 s22, s40, 2
    s_add_u32 s22, s22, s20
    s_waitcnt lgkmcnt(0)
    s_mov_b32 s8, s4
    s_mov_b32 s9, s5
    s_mov_b32 s10, 3670016
    s_mov_b32 s11, 0x00020000
    s_mov_b32 s24, s18
    s_mov_b32 s25, s19
    s_mov_b32 s26, 3670016
    s_mov_b32 s27, 0x00020000
    s_mov_b32 s12, s6
    s_mov_b32 s13, s7
    s_mov_b32 s14, 268435456
    s_mov_b32 s15, 0x00020000
    s_lshl_b32 s23, s21, 9
    v_lshrrev_b32 v12, 5, v0
    v_and_b32 v13, 31, v0
    v_lshlrev_b32 v14, 13, v12
    v_lshl_add_u32 v14, v13, 4, v14
    v_mul_u32_u24 v15, 528, v12
    v_lshl_add_u32 v15, v13, 4, v15
    v_add_u32 v15, 0, v15
    s_lshl_b32 s30, s39, 18
    s_add_u32 s30, s30, s23
    s_add_u32 s30, s30, 0
    buffer_load_dwordx4 v[64:67], v14, s[8:11], s30 offen
    s_lshl_b32 s30, s39, 18
    s_add_u32 s30, s30, s23
    s_add_u32 s30, s30, 65536
    buffer_load_dwordx4 v[68:71], v14, s[8:11], s30 offen
    s_lshl_b32 s30, s39, 18
    s_add_u32 s30, s30, s23
    s_add_u32 s30, s30, 131072
    buffer_load_dwordx4 v[72:75], v14, s[8:11], s30 offen
    s_lshl_b32 s30, s39, 18
    s_add_u32 s30, s30, s23
    s_add_u32 s30, s30, 196608
    buffer_load_dwordx4 v[76:79], v14, s[8:11], s30 offen
    s_lshl_b32 s30, s39, 18
    s_add_u32 s30, s30, s23
    s_add_u32 s30, s30, 1835008
    buffer_load_dwordx4 v[80:83], v14, s[8:11], s30 offen
    s_lshl_b32 s30, s39, 18
    s_add_u32 s30, s30, s23
    s_add_u32 s30, s30, 1900544
    buffer_load_dwordx4 v[84:87], v14, s[8:11], s30 offen
    s_lshl_b32 s30, s39, 18
    s_add_u32 s30, s30, s23
    s_add_u32 s30, s30, 1966080
    buffer_load_dwordx4 v[88:91], v14, s[8:11], s30 offen
    s_lshl_b32 s30, s39, 18
    s_add_u32 s30, s30, s23
    s_add_u32 s30, s30, 2031616
    buffer_load_dwordx4 v[92:95], v14, s[8:11], s30 offen
    s_lshl_b32 s28, s22, 17
    s_add_u32 s28, s28, s23
    buffer_load_dwordx4 v[32:35], v5, s[24:27], s28 offen offset:0
    buffer_load_dwordx4 v[36:39], v5, s[24:27], s28 offen offset:64
    buffer_load_dwordx4 v[40:43], v5, s[24:27], s28 offen offset:128
    buffer_load_dwordx4 v[44:47], v5, s[24:27], s28 offen offset:192
    buffer_load_dwordx4 v[48:51], v5, s[24:27], s28 offen offset:256
    buffer_load_dwordx4 v[52:55], v5, s[24:27], s28 offen offset:320
    buffer_load_dwordx4 v[56:59], v5, s[24:27], s28 offen offset:384
    buffer_load_dwordx4 v[60:63], v5, s[24:27], s28 offen offset:448
    s_waitcnt vmcnt(0)
    ds_write_b128 v15, v[64:67] offset:0
    ds_write_b128 v15, v[68:71] offset:4224
    ds_write_b128 v15, v[72:75] offset:8448
    ds_write_b128 v15, v[76:79] offset:12672
    ds_write_b128 v15, v[80:83] offset:16896
    ds_write_b128 v15, v[84:87] offset:21120
    ds_write_b128 v15, v[88:91] offset:25344
    ds_write_b128 v15, v[92:95] offset:29568
    v_mov_b32 v112, 0
    v_mov_b32 v113, 0
    v_mov_b32 v114, 0
    v_mov_b32 v115, 0
    v_mov_b32 v116, 0
    v_mov_b32 v117, 0
    v_mov_b32 v118, 0
    v_mov_b32 v119, 0
    v_mov_b32 v120, 0
    v_mov_b32 v121, 0
    v_mov_b32 v122, 0
    v_mov_b32 v123, 0
    v_mov_b32 v124, 0
    v_mov_b32 v125, 0
    v_mov_b32 v126, 0
    v_mov_b32 v127, 0
    s_waitcnt lgkmcnt(0)
    s_barrier
    v_mul_u32_u24 v12, 528, v3
    v_lshl_add_u32 v12, v4, 4, v12
    v_add_u32 v12, 0, v12
    ds_read_b128 v[64:67], v12 offset:0
    ds_read_b128 v[68:71], v12 offset:64
    ds_read_b128 v[72:75], v12 offset:128
    ds_read_b128 v[76:79], v12 offset:192
    ds_read_b128 v[80:83], v12 offset:256
    ds_read_b128 v[84:87], v12 offset:320
    ds_read_b128 v[88:91], v12 offset:384
    ds_read_b128 v[92:95], v12 offset:448
    s_waitcnt lgkmcnt(0)
    v_mfma_f32_16x16x32_bf16 v[112:115], v[64:67], v[32:35], v[112:115]
    v_mfma_f32_16x16x32_bf16 v[112:115], v[68:71], v[36:39], v[112:115]
    v_mfma_f32_16x16x32_bf16 v[112:115], v[72:75], v[40:43], v[112:115]
    v_mfma_f32_16x16x32_bf16 v[112:115], v[76:79], v[44:47], v[112:115]
    v_mfma_f32_16x16x32_bf16 v[112:115], v[80:83], v[48:51], v[112:115]
    v_mfma_f32_16x16x32_bf16 v[112:115], v[84:87], v[52:55], v[112:115]
    v_mfma_f32_16x16x32_bf16 v[112:115], v[88:91], v[56:59], v[112:115]
    v_mfma_f32_16x16x32_bf16 v[112:115], v[92:95], v[60:63], v[112:115]
    ds_read_b128 v[64:67], v12 offset:8448
    ds_read_b128 v[68:71], v12 offset:8512
    ds_read_b128 v[72:75], v12 offset:8576
    ds_read_b128 v[76:79], v12 offset:8640
    ds_read_b128 v[80:83], v12 offset:8704
    ds_read_b128 v[84:87], v12 offset:8768
    ds_read_b128 v[88:91], v12 offset:8832
    ds_read_b128 v[92:95], v12 offset:8896
    s_waitcnt lgkmcnt(0)
    v_mfma_f32_16x16x32_bf16 v[116:119], v[64:67], v[32:35], v[116:119]
    v_mfma_f32_16x16x32_bf16 v[116:119], v[68:71], v[36:39], v[116:119]
    v_mfma_f32_16x16x32_bf16 v[116:119], v[72:75], v[40:43], v[116:119]
    v_mfma_f32_16x16x32_bf16 v[116:119], v[76:79], v[44:47], v[116:119]
    v_mfma_f32_16x16x32_bf16 v[116:119], v[80:83], v[48:51], v[116:119]
    v_mfma_f32_16x16x32_bf16 v[116:119], v[84:87], v[52:55], v[116:119]
    v_mfma_f32_16x16x32_bf16 v[116:119], v[88:91], v[56:59], v[116:119]
    v_mfma_f32_16x16x32_bf16 v[116:119], v[92:95], v[60:63], v[116:119]
    ds_read_b128 v[64:67], v12 offset:16896
    ds_read_b128 v[68:71], v12 offset:16960
    ds_read_b128 v[72:75], v12 offset:17024
    ds_read_b128 v[76:79], v12 offset:17088
    ds_read_b128 v[80:83], v12 offset:17152
    ds_read_b128 v[84:87], v12 offset:17216
    ds_read_b128 v[88:91], v12 offset:17280
    ds_read_b128 v[92:95], v12 offset:17344
    s_waitcnt lgkmcnt(0)
    v_mfma_f32_16x16x32_bf16 v[120:123], v[64:67], v[32:35], v[120:123]
    v_mfma_f32_16x16x32_bf16 v[120:123], v[68:71], v[36:39], v[120:123]
    v_mfma_f32_16x16x32_bf16 v[120:123], v[72:75], v[40:43], v[120:123]
    v_mfma_f32_16x16x32_bf16 v[120:123], v[76:79], v[44:47], v[120:123]
    v_mfma_f32_16x16x32_bf16 v[120:123], v[80:83], v[48:51], v[120:123]
    v_mfma_f32_16x16x32_bf16 v[120:123], v[84:87], v[52:55], v[120:123]
    v_mfma_f32_16x16x32_bf16 v[120:123], v[88:91], v[56:59], v[120:123]
    v_mfma_f32_16x16x32_bf16 v[120:123], v[92:95], v[60:63], v[120:123]
    ds_read_b128 v[64:67], v12 offset:25344
    ds_read_b128 v[68:71], v12 offset:25408
    ds_read_b128 v[72:75], v12 offset:25472
    ds_read_b128 v[76:79], v12 offset:25536
    ds_read_b128 v[80:83], v12 offset:25600
    ds_read_b128 v[84:87], v12 offset:25664
    ds_read_b128 v[88:91], v12 offset:25728
    ds_read_b128 v[92:95], v12 offset:25792
    s_waitcnt lgkmcnt(0)
    v_mfma_f32_16x16x32_bf16 v[124:127], v[64:67], v[32:35], v[124:127]
    v_mfma_f32_16x16x32_bf16 v[124:127], v[68:71], v[36:39], v[124:127]
    v_mfma_f32_16x16x32_bf16 v[124:127], v[72:75], v[40:43], v[124:127]
    v_mfma_f32_16x16x32_bf16 v[124:127], v[76:79], v[44:47], v[124:127]
    v_mfma_f32_16x16x32_bf16 v[124:127], v[80:83], v[48:51], v[124:127]
    v_mfma_f32_16x16x32_bf16 v[124:127], v[84:87], v[52:55], v[124:127]
    v_mfma_f32_16x16x32_bf16 v[124:127], v[88:91], v[56:59], v[124:127]
    v_mfma_f32_16x16x32_bf16 v[124:127], v[92:95], v[60:63], v[124:127]
    v_lshrrev_b32 v6, 1, v4
    v_lshl_add_u32 v6, v6, 4, v3
    v_lshlrev_b32 v6, 4, v6
    v_and_b32 v7, 1, v4
    v_lshl_add_u32 v6, v7, 3, v6
    s_lshl_b32 s31, s20, 11
    s_add_u32 s31, s31, 0
    v_add_u32 v6, s31, v6
    s_and_b32 s31, s20, 1
    s_lshl_b32 s31, s31, 4
    v_add_u32 v8, s31, v3
    v_lshrrev_b32 v9, 2, v8
    v_lshlrev_b32 v9, 1, v9
    v_and_b32 v10, 1, v8
    v_add_u32 v9, v9, v10
    v_lshl_add_u32 v9, v4, 4, v9
    v_lshlrev_b32 v9, 4, v9
    v_bfe_u32 v10, v8, 1, 1
    v_lshl_add_u32 v9, v10, 11, v9
    s_lshr_b32 s31, s20, 1
    s_lshl_b32 s31, s31, 12
    s_add_u32 s31, s31, 8192
    v_add_u32 v9, s31, v9
    s_nop 4
    s_barrier
    v_mul_f32 v112, 0.09016844005556021, v112
    v_mul_f32 v113, 0.09016844005556021, v113
    v_mul_f32 v114, 0.09016844005556021, v114
    v_mul_f32 v115, 0.09016844005556021, v115
    v_cvt_pk_bf16_f32 v16, v112, v113
    v_cvt_pk_bf16_f32 v17, v114, v115
    ds_write_b64 v6, v[16:17] offset:0
    ds_write_b32 v9, v16 offset:0
    ds_write_b32 v9, v17 offset:8
    v_mul_f32 v116, 0.09016844005556021, v116
    v_mul_f32 v117, 0.09016844005556021, v117
    v_mul_f32 v118, 0.09016844005556021, v118
    v_mul_f32 v119, 0.09016844005556021, v119
    v_cvt_pk_bf16_f32 v16, v116, v117
    v_cvt_pk_bf16_f32 v17, v118, v119
    ds_write_b64 v6, v[16:17] offset:512
    ds_write_b32 v9, v16 offset:1024
    ds_write_b32 v9, v17 offset:1032
    v_mul_f32 v120, 0.09016844005556021, v120
    v_mul_f32 v121, 0.09016844005556021, v121
    v_mul_f32 v122, 0.09016844005556021, v122
    v_mul_f32 v123, 0.09016844005556021, v123
    v_cvt_pk_bf16_f32 v16, v120, v121
    v_cvt_pk_bf16_f32 v17, v122, v123
    ds_write_b64 v6, v[16:17] offset:1024
    ds_write_b32 v9, v16 offset:4
    ds_write_b32 v9, v17 offset:12
    v_mul_f32 v124, 0.09016844005556021, v124
    v_mul_f32 v125, 0.09016844005556021, v125
    v_mul_f32 v126, 0.09016844005556021, v126
    v_mul_f32 v127, 0.09016844005556021, v127
    v_cvt_pk_bf16_f32 v16, v124, v125
    v_cvt_pk_bf16_f32 v17, v126, v127
    ds_write_b64 v6, v[16:17] offset:1536
    ds_write_b32 v9, v16 offset:1028
    ds_write_b32 v9, v17 offset:1036
    s_waitcnt lgkmcnt(0)
    s_barrier
    s_lshl_b32 s31, s20, 11
    s_add_u32 s31, s31, 0
    v_add_u32 v6, s31, v11
    ds_read_b128 v[16:19], v6
    ds_read_b128 v[20:23], v6 offset:1024
    s_lshl_b32 s31, s20, 11
    s_add_u32 s31, s31, 8192
    v_add_u32 v7, s31, v11
    ds_read_b128 v[24:27], v7
    ds_read_b128 v[28:31], v7 offset:1024
    s_mul_i32 s30, s21, 28
    s_add_u32 s30, s30, s22
    s_mul_i32 s31, s30, 14
    s_add_u32 s31, s31, s39
    s_lshl_b32 s31, s31, 10
    s_add_u32 s31, s31, 2097152
    s_add_u32 s32, s31, 7168
    s_mul_i32 s33, s30, 7
    s_add_u32 s33, s33, s39
    s_lshl_b32 s33, s33, 11
    s_add_u32 s33, s33, 9437184
    s_waitcnt lgkmcnt(0)
    buffer_store_dwordx4 v[16:19], v11, s[12:15], s31 offen
    buffer_store_dwordx4 v[20:23], v11, s[12:15], s32 offen
    buffer_store_dwordx4 v[24:27], v11, s[12:15], s33 offen
    buffer_store_dwordx4 v[28:31], v11, s[12:15], s33 offen offset:1024
    s_endpgm
P_VO:
    s_load_dwordx2 s[4:5], s[0:1], 32
    s_load_dwordx2 s[18:19], s[0:1], 40
    s_sub_u32 s3, s2, 1296
    v_and_b32 v3, 15, v2
    v_lshrrev_b32 v4, 4, v2
    v_lshlrev_b32 v5, 13, v3
    v_lshl_add_u32 v5, v4, 4, v5
    v_lshlrev_b32 v11, 4, v2
    s_and_b32 s36, s3, 7
    s_lshr_b32 s37, s3, 3
    s_mul_i32 s3, s36, 196
    s_add_u32 s3, s3, s37
    s_mul_i32 s38, s3, 74899
    s_lshr_b32 s38, s38, 20
    s_mul_i32 s39, s38, 14
    s_sub_u32 s39, s3, s39
    s_mul_i32 s42, s38, 4682
    s_lshr_b32 s42, s42, 16
    s_mul_i32 s40, s42, 14
    s_sub_u32 s40, s38, s40
    s_lshr_b32 s21, s20, 1
    s_lshl_b32 s22, s42, 1
    s_add_u32 s21, s21, s22
    s_and_b32 s22, s20, 1
    s_lshl_b32 s23, s40, 1
    s_add_u32 s22, s22, s23
    s_waitcnt lgkmcnt(0)
    s_mov_b32 s8, s4
    s_mov_b32 s9, s5
    s_mov_b32 s10, 3670016
    s_mov_b32 s11, 0x00020000
    s_mov_b32 s24, s18
    s_mov_b32 s25, s19
    s_mov_b32 s26, 3670016
    s_mov_b32 s27, 0x00020000
    s_mov_b32 s12, s6
    s_mov_b32 s13, s7
    s_mov_b32 s14, 268435456
    s_mov_b32 s15, 0x00020000
    s_lshl_b32 s23, s21, 9
    v_lshrrev_b32 v12, 5, v0
    v_and_b32 v13, 31, v0
    v_lshlrev_b32 v14, 13, v12
    v_lshl_add_u32 v14, v13, 4, v14
    v_mul_u32_u24 v15, 528, v12
    v_lshl_add_u32 v15, v13, 4, v15
    v_add_u32 v15, 0, v15
    s_lshl_b32 s30, s39, 18
    s_lshl_b32 s31, s42, 10
    s_add_u32 s30, s30, s31
    s_add_u32 s30, s30, 0
    buffer_load_dwordx4 v[64:67], v14, s[8:11], s30 offen
    s_lshl_b32 s30, s39, 18
    s_lshl_b32 s31, s42, 10
    s_add_u32 s30, s30, s31
    s_add_u32 s30, s30, 65536
    buffer_load_dwordx4 v[68:71], v14, s[8:11], s30 offen
    s_lshl_b32 s30, s39, 18
    s_lshl_b32 s31, s42, 10
    s_add_u32 s30, s30, s31
    s_add_u32 s30, s30, 131072
    buffer_load_dwordx4 v[72:75], v14, s[8:11], s30 offen
    s_lshl_b32 s30, s39, 18
    s_lshl_b32 s31, s42, 10
    s_add_u32 s30, s30, s31
    s_add_u32 s30, s30, 196608
    buffer_load_dwordx4 v[76:79], v14, s[8:11], s30 offen
    s_lshl_b32 s30, s39, 18
    s_lshl_b32 s31, s42, 10
    s_add_u32 s30, s30, s31
    s_add_u32 s30, s30, 512
    buffer_load_dwordx4 v[80:83], v14, s[8:11], s30 offen
    s_lshl_b32 s30, s39, 18
    s_lshl_b32 s31, s42, 10
    s_add_u32 s30, s30, s31
    s_add_u32 s30, s30, 66048
    buffer_load_dwordx4 v[84:87], v14, s[8:11], s30 offen
    s_lshl_b32 s30, s39, 18
    s_lshl_b32 s31, s42, 10
    s_add_u32 s30, s30, s31
    s_add_u32 s30, s30, 131584
    buffer_load_dwordx4 v[88:91], v14, s[8:11], s30 offen
    s_lshl_b32 s30, s39, 18
    s_lshl_b32 s31, s42, 10
    s_add_u32 s30, s30, s31
    s_add_u32 s30, s30, 197120
    buffer_load_dwordx4 v[92:95], v14, s[8:11], s30 offen
    v_lshrrev_b32 v6, 2, v0
    v_and_b32 v7, 3, v0
    v_mul_u32_u24 v8, 896, v6
    v_lshl_add_u32 v8, v7, 4, v8
    v_mul_u32_u24 v9, 80, v6
    v_lshl_add_u32 v9, v7, 4, v9
    s_mul_i32 s28, s42, 458752
    s_lshl_b32 s31, s40, 6
    s_add_u32 s28, s28, s31
    s_add_u32 s31, s28, 0
    buffer_load_dwordx4 v[96:99], v8, s[24:27], s31 offen
    s_add_u32 s31, s28, 57344
    buffer_load_dwordx4 v[100:103], v8, s[24:27], s31 offen
    s_add_u32 s31, s28, 114688
    buffer_load_dwordx4 v[104:107], v8, s[24:27], s31 offen
    s_add_u32 s31, s28, 172032
    buffer_load_dwordx4 v[108:111], v8, s[24:27], s31 offen
    s_add_u32 s31, s28, 229376
    buffer_load_dwordx4 v[112:115], v8, s[24:27], s31 offen
    s_add_u32 s31, s28, 286720
    buffer_load_dwordx4 v[116:119], v8, s[24:27], s31 offen
    s_add_u32 s31, s28, 344064
    buffer_load_dwordx4 v[120:123], v8, s[24:27], s31 offen
    s_add_u32 s31, s28, 401408
    buffer_load_dwordx4 v[124:127], v8, s[24:27], s31 offen
    s_waitcnt vmcnt(0)
    ds_write_b128 v9, v[96:99] offset:0
    ds_write_b128 v9, v[100:103] offset:5120
    ds_write_b128 v9, v[104:107] offset:10240
    ds_write_b128 v9, v[108:111] offset:15360
    ds_write_b128 v9, v[112:115] offset:20480
    ds_write_b128 v9, v[116:119] offset:25600
    ds_write_b128 v9, v[120:123] offset:30720
    ds_write_b128 v9, v[124:127] offset:35840
    s_waitcnt lgkmcnt(0)
    s_barrier
    v_lshrrev_b32 v6, 2, v3
    v_lshl_add_u32 v6, v4, 3, v6
    v_mul_u32_u24 v6, 80, v6
    v_and_b32 v7, 3, v3
    v_lshl_add_u32 v6, v7, 3, v6
    s_lshr_b32 s31, s20, 1
    s_mul_i32 s31, s31, 20480
    s_and_b32 s32, s20, 1
    s_lshl_b32 s32, s32, 5
    s_add_u32 s31, s31, s32
    v_add_u32 v6, s31, v6
    ds_read_b64_tr_b16 v[32:33], v6 offset:0
    ds_read_b64_tr_b16 v[34:35], v6 offset:320
    ds_read_b64_tr_b16 v[36:37], v6 offset:2560
    ds_read_b64_tr_b16 v[38:39], v6 offset:2880
    ds_read_b64_tr_b16 v[40:41], v6 offset:5120
    ds_read_b64_tr_b16 v[42:43], v6 offset:5440
    ds_read_b64_tr_b16 v[44:45], v6 offset:7680
    ds_read_b64_tr_b16 v[46:47], v6 offset:8000
    ds_read_b64_tr_b16 v[48:49], v6 offset:10240
    ds_read_b64_tr_b16 v[50:51], v6 offset:10560
    ds_read_b64_tr_b16 v[52:53], v6 offset:12800
    ds_read_b64_tr_b16 v[54:55], v6 offset:13120
    ds_read_b64_tr_b16 v[56:57], v6 offset:15360
    ds_read_b64_tr_b16 v[58:59], v6 offset:15680
    ds_read_b64_tr_b16 v[60:61], v6 offset:17920
    ds_read_b64_tr_b16 v[62:63], v6 offset:18240
    s_waitcnt lgkmcnt(0)
    s_waitcnt vmcnt(0)
    s_barrier
    ds_write_b128 v15, v[64:67] offset:0
    ds_write_b128 v15, v[68:71] offset:4224
    ds_write_b128 v15, v[72:75] offset:8448
    ds_write_b128 v15, v[76:79] offset:12672
    ds_write_b128 v15, v[80:83] offset:16896
    ds_write_b128 v15, v[84:87] offset:21120
    ds_write_b128 v15, v[88:91] offset:25344
    ds_write_b128 v15, v[92:95] offset:29568
    v_mov_b32 v112, 0
    v_mov_b32 v113, 0
    v_mov_b32 v114, 0
    v_mov_b32 v115, 0
    v_mov_b32 v116, 0
    v_mov_b32 v117, 0
    v_mov_b32 v118, 0
    v_mov_b32 v119, 0
    s_waitcnt lgkmcnt(0)
    s_barrier
    v_mul_u32_u24 v12, 528, v3
    v_lshl_add_u32 v12, v4, 4, v12
    v_add_u32 v12, 0, v12
    s_lshr_b32 s30, s20, 1
    s_mul_i32 s30, s30, 16896
    v_add_u32 v12, s30, v12
    ds_read_b128 v[64:67], v12 offset:0
    ds_read_b128 v[68:71], v12 offset:64
    ds_read_b128 v[72:75], v12 offset:128
    ds_read_b128 v[76:79], v12 offset:192
    ds_read_b128 v[80:83], v12 offset:256
    ds_read_b128 v[84:87], v12 offset:320
    ds_read_b128 v[88:91], v12 offset:384
    ds_read_b128 v[92:95], v12 offset:448
    s_waitcnt lgkmcnt(0)
    v_mfma_f32_16x16x32_bf16 v[112:115], v[64:67], v[32:35], v[112:115]
    v_mfma_f32_16x16x32_bf16 v[112:115], v[68:71], v[36:39], v[112:115]
    v_mfma_f32_16x16x32_bf16 v[112:115], v[72:75], v[40:43], v[112:115]
    v_mfma_f32_16x16x32_bf16 v[112:115], v[76:79], v[44:47], v[112:115]
    v_mfma_f32_16x16x32_bf16 v[112:115], v[80:83], v[48:51], v[112:115]
    v_mfma_f32_16x16x32_bf16 v[112:115], v[84:87], v[52:55], v[112:115]
    v_mfma_f32_16x16x32_bf16 v[112:115], v[88:91], v[56:59], v[112:115]
    v_mfma_f32_16x16x32_bf16 v[112:115], v[92:95], v[60:63], v[112:115]
    ds_read_b128 v[64:67], v12 offset:8448
    ds_read_b128 v[68:71], v12 offset:8512
    ds_read_b128 v[72:75], v12 offset:8576
    ds_read_b128 v[76:79], v12 offset:8640
    ds_read_b128 v[80:83], v12 offset:8704
    ds_read_b128 v[84:87], v12 offset:8768
    ds_read_b128 v[88:91], v12 offset:8832
    ds_read_b128 v[92:95], v12 offset:8896
    s_waitcnt lgkmcnt(0)
    v_mfma_f32_16x16x32_bf16 v[116:119], v[64:67], v[32:35], v[116:119]
    v_mfma_f32_16x16x32_bf16 v[116:119], v[68:71], v[36:39], v[116:119]
    v_mfma_f32_16x16x32_bf16 v[116:119], v[72:75], v[40:43], v[116:119]
    v_mfma_f32_16x16x32_bf16 v[116:119], v[76:79], v[44:47], v[116:119]
    v_mfma_f32_16x16x32_bf16 v[116:119], v[80:83], v[48:51], v[116:119]
    v_mfma_f32_16x16x32_bf16 v[116:119], v[84:87], v[52:55], v[116:119]
    v_mfma_f32_16x16x32_bf16 v[116:119], v[88:91], v[56:59], v[116:119]
    v_mfma_f32_16x16x32_bf16 v[116:119], v[92:95], v[60:63], v[116:119]
    v_lshrrev_b32 v6, 1, v4
    v_lshl_add_u32 v6, v6, 4, v3
    v_lshlrev_b32 v6, 4, v6
    v_and_b32 v7, 1, v4
    v_lshl_add_u32 v6, v7, 3, v6
    s_lshl_b32 s31, s20, 10
    s_add_u32 s31, s31, 0
    v_add_u32 v6, s31, v6
    v_lshl_add_u32 v9, v4, 4, v3
    v_lshlrev_b32 v9, 4, v9
    s_and_b32 s31, s20, 1
    s_lshl_b32 s31, s31, 11
    s_lshr_b32 s32, s20, 1
    s_lshl_b32 s32, s32, 2
    s_add_u32 s31, s31, s32
    s_add_u32 s31, s31, 4096
    v_add_u32 v9, s31, v9
    s_nop 4
    s_barrier
    v_cvt_pk_bf16_f32 v16, v112, v113
    v_cvt_pk_bf16_f32 v17, v114, v115
    ds_write_b64 v6, v[16:17] offset:0
    ds_write_b32 v9, v16 offset:0
    ds_write_b32 v9, v17 offset:8
    v_cvt_pk_bf16_f32 v16, v116, v117
    v_cvt_pk_bf16_f32 v17, v118, v119
    ds_write_b64 v6, v[16:17] offset:512
    ds_write_b32 v9, v16 offset:1024
    ds_write_b32 v9, v17 offset:1032
    s_waitcnt lgkmcnt(0)
    s_barrier
    s_lshl_b32 s31, s20, 10
    s_add_u32 s31, s31, 0
    v_add_u32 v6, s31, v11
    ds_read_b128 v[16:19], v6
    ds_read_b128 v[20:23], v6 offset:4096
    s_mul_i32 s30, s21, 28
    s_add_u32 s30, s30, s22
    s_mul_i32 s31, s30, 14
    s_add_u32 s31, s31, s39
    s_lshl_b32 s31, s31, 10
    s_add_u32 s31, s31, 16777216
    s_lshl_b32 s32, s40, 2
    s_lshr_b32 s33, s42, 1
    s_add_u32 s32, s32, s33
    s_lshl_b32 s32, s32, 2
    s_lshr_b32 s33, s20, 1
    s_lshl_b32 s33, s33, 1
    s_add_u32 s32, s32, s33
    s_and_b32 s33, s42, 1
    s_add_u32 s32, s32, s33
    s_mul_i32 s32, s32, 14
    s_add_u32 s32, s32, s39
    s_lshl_b32 s32, s32, 11
    s_and_b32 s33, s20, 1
    s_lshl_b32 s33, s33, 10
    s_add_u32 s32, s32, s33
    s_add_u32 s32, s32, 85983232
    s_waitcnt lgkmcnt(0)
    buffer_store_dwordx4 v[16:19], v11, s[12:15], s31 offen
    buffer_store_dwordx4 v[20:23], v11, s[12:15], s32 offen
    s_endpgm
P_REP:
    s_load_dwordx4 s[16:19], s[0:1], 64
    s_load_dwordx2 s[4:5], s[0:1], 80
    s_sub_u32 s3, s2, 2864
    s_lshl_b32 s3, s3, 2
    s_add_u32 s3, s3, s20
    v_and_b32 v3, 15, v2
    v_lshrrev_b32 v4, 4, v2
    s_waitcnt lgkmcnt(0)
    s_mov_b32 s12, s6
    s_mov_b32 s13, s7
    s_mov_b32 s14, 268435456
    s_mov_b32 s15, 0x00020000
    s_cmp_lt_u32 s3, 784
    s_cbranch_scc0 P_REP_D
    s_cmp_lt_u32 s3, 392
    s_cselect_b32 s8, s16, s18
    s_cselect_b32 s9, s17, s19
    s_mov_b32 s22, 26214400
    s_cselect_b32 s22, 24117248, s22
    s_cselect_b32 s23, 0, 392
    s_mov_b32 s10, 1605632
    s_mov_b32 s11, 0x00020000
    s_sub_u32 s3, s3, s23
    s_lshl_b32 s3, s3, 2
    v_mul_u32_u24 v5, 28672, v4
    v_lshl_add_u32 v5, v3, 1, v5
    s_add_u32 s24, s3, 0
    s_mul_i32 s25, s24, 4682
    s_lshr_b32 s25, s25, 16
    s_mul_i32 s26, s25, 14
    s_sub_u32 s26, s24, s26
    s_mul_i32 s26, s26, 114688
    s_lshl_b32 s25, s25, 5
    s_add_u32 s26, s26, s25
    buffer_load_ushort v16, v5, s[8:11], s26 offen offset:0
    buffer_load_ushort v17, v5, s[8:11], s26 offen offset:3584
    s_add_u32 s27, s26, 7168
    buffer_load_ushort v18, v5, s[8:11], s27 offen
    s_add_u32 s27, s26, 10752
    buffer_load_ushort v19, v5, s[8:11], s27 offen
    s_add_u32 s27, s26, 14336
    buffer_load_ushort v20, v5, s[8:11], s27 offen
    s_add_u32 s27, s26, 17920
    buffer_load_ushort v21, v5, s[8:11], s27 offen
    s_add_u32 s27, s26, 21504
    buffer_load_ushort v22, v5, s[8:11], s27 offen
    s_add_u32 s27, s26, 25088
    buffer_load_ushort v23, v5, s[8:11], s27 offen
    s_add_u32 s24, s3, 1
    s_mul_i32 s25, s24, 4682
    s_lshr_b32 s25, s25, 16
    s_mul_i32 s26, s25, 14
    s_sub_u32 s26, s24, s26
    s_mul_i32 s26, s26, 114688
    s_lshl_b32 s25, s25, 5
    s_add_u32 s26, s26, s25
    buffer_load_ushort v24, v5, s[8:11], s26 offen offset:0
    buffer_load_ushort v25, v5, s[8:11], s26 offen offset:3584
    s_add_u32 s27, s26, 7168
    buffer_load_ushort v26, v5, s[8:11], s27 offen
    s_add_u32 s27, s26, 10752
    buffer_load_ushort v27, v5, s[8:11], s27 offen
    s_add_u32 s27, s26, 14336
    buffer_load_ushort v28, v5, s[8:11], s27 offen
    s_add_u32 s27, s26, 17920
    buffer_load_ushort v29, v5, s[8:11], s27 offen
    s_add_u32 s27, s26, 21504
    buffer_load_ushort v30, v5, s[8:11], s27 offen
    s_add_u32 s27, s26, 25088
    buffer_load_ushort v31, v5, s[8:11], s27 offen
    s_add_u32 s24, s3, 2
    s_mul_i32 s25, s24, 4682
    s_lshr_b32 s25, s25, 16
    s_mul_i32 s26, s25, 14
    s_sub_u32 s26, s24, s26
    s_mul_i32 s26, s26, 114688
    s_lshl_b32 s25, s25, 5
    s_add_u32 s26, s26, s25
    buffer_load_ushort v32, v5, s[8:11], s26 offen offset:0
    buffer_load_ushort v33, v5, s[8:11], s26 offen offset:3584
    s_add_u32 s27, s26, 7168
    buffer_load_ushort v34, v5, s[8:11], s27 offen
    s_add_u32 s27, s26, 10752
    buffer_load_ushort v35, v5, s[8:11], s27 offen
    s_add_u32 s27, s26, 14336
    buffer_load_ushort v36, v5, s[8:11], s27 offen
    s_add_u32 s27, s26, 17920
    buffer_load_ushort v37, v5, s[8:11], s27 offen
    s_add_u32 s27, s26, 21504
    buffer_load_ushort v38, v5, s[8:11], s27 offen
    s_add_u32 s27, s26, 25088
    buffer_load_ushort v39, v5, s[8:11], s27 offen
    s_add_u32 s24, s3, 3
    s_mul_i32 s25, s24, 4682
    s_lshr_b32 s25, s25, 16
    s_mul_i32 s26, s25, 14
    s_sub_u32 s26, s24, s26
    s_mul_i32 s26, s26, 114688
    s_lshl_b32 s25, s25, 5
    s_add_u32 s26, s26, s25
    buffer_load_ushort v40, v5, s[8:11], s26 offen offset:0
    buffer_load_ushort v41, v5, s[8:11], s26 offen offset:3584
    s_add_u32 s27, s26, 7168
    buffer_load_ushort v42, v5, s[8:11], s27 offen
    s_add_u32 s27, s26, 10752
    buffer_load_ushort v43, v5, s[8:11], s27 offen
    s_add_u32 s27, s26, 14336
    buffer_load_ushort v44, v5, s[8:11], s27 offen
    s_add_u32 s27, s26, 17920
    buffer_load_ushort v45, v5, s[8:11], s27 offen
    s_add_u32 s27, s26, 21504
    buffer_load_ushort v46, v5, s[8:11], s27 offen
    s_add_u32 s27, s26, 25088
    buffer_load_ushort v47, v5, s[8:11], s27 offen
    s_branch P_REP_ST
P_REP_D:
    s_mov_b32 s8, s4
    s_mov_b32 s9, s5
    s_mov_b32 s10, 1605632
    s_mov_b32 s11, 0x00020000
    s_mov_b32 s22, 28311552
    s_sub_u32 s3, s3, 784
    s_lshl_b32 s3, s3, 2
    v_mul_u32_u24 v5, 7168, v4
    v_lshl_add_u32 v5, v3, 1, v5
    s_add_u32 s24, s3, 0
    s_mul_i32 s25, s24, 1171
    s_lshr_b32 s25, s25, 16
    s_mul_i32 s26, s25, 56
    s_sub_u32 s26, s24, s26
    s_mul_i32 s26, s26, 28672
    s_lshl_b32 s25, s25, 5
    s_add_u32 s26, s26, s25
    buffer_load_ushort v16, v5, s[8:11], s26 offen offset:0
    buffer_load_ushort v17, v5, s[8:11], s26 offen offset:896
    buffer_load_ushort v18, v5, s[8:11], s26 offen offset:1792
    buffer_load_ushort v19, v5, s[8:11], s26 offen offset:2688
    buffer_load_ushort v20, v5, s[8:11], s26 offen offset:3584
    s_add_u32 s27, s26, 4480
    buffer_load_ushort v21, v5, s[8:11], s27 offen
    s_add_u32 s27, s26, 5376
    buffer_load_ushort v22, v5, s[8:11], s27 offen
    s_add_u32 s27, s26, 6272
    buffer_load_ushort v23, v5, s[8:11], s27 offen
    s_add_u32 s24, s3, 1
    s_mul_i32 s25, s24, 1171
    s_lshr_b32 s25, s25, 16
    s_mul_i32 s26, s25, 56
    s_sub_u32 s26, s24, s26
    s_mul_i32 s26, s26, 28672
    s_lshl_b32 s25, s25, 5
    s_add_u32 s26, s26, s25
    buffer_load_ushort v24, v5, s[8:11], s26 offen offset:0
    buffer_load_ushort v25, v5, s[8:11], s26 offen offset:896
    buffer_load_ushort v26, v5, s[8:11], s26 offen offset:1792
    buffer_load_ushort v27, v5, s[8:11], s26 offen offset:2688
    buffer_load_ushort v28, v5, s[8:11], s26 offen offset:3584
    s_add_u32 s27, s26, 4480
    buffer_load_ushort v29, v5, s[8:11], s27 offen
    s_add_u32 s27, s26, 5376
    buffer_load_ushort v30, v5, s[8:11], s27 offen
    s_add_u32 s27, s26, 6272
    buffer_load_ushort v31, v5, s[8:11], s27 offen
    s_add_u32 s24, s3, 2
    s_mul_i32 s25, s24, 1171
    s_lshr_b32 s25, s25, 16
    s_mul_i32 s26, s25, 56
    s_sub_u32 s26, s24, s26
    s_mul_i32 s26, s26, 28672
    s_lshl_b32 s25, s25, 5
    s_add_u32 s26, s26, s25
    buffer_load_ushort v32, v5, s[8:11], s26 offen offset:0
    buffer_load_ushort v33, v5, s[8:11], s26 offen offset:896
    buffer_load_ushort v34, v5, s[8:11], s26 offen offset:1792
    buffer_load_ushort v35, v5, s[8:11], s26 offen offset:2688
    buffer_load_ushort v36, v5, s[8:11], s26 offen offset:3584
    s_add_u32 s27, s26, 4480
    buffer_load_ushort v37, v5, s[8:11], s27 offen
    s_add_u32 s27, s26, 5376
    buffer_load_ushort v38, v5, s[8:11], s27 offen
    s_add_u32 s27, s26, 6272
    buffer_load_ushort v39, v5, s[8:11], s27 offen
    s_add_u32 s24, s3, 3
    s_mul_i32 s25, s24, 1171
    s_lshr_b32 s25, s25, 16
    s_mul_i32 s26, s25, 56
    s_sub_u32 s26, s24, s26
    s_mul_i32 s26, s26, 28672
    s_lshl_b32 s25, s25, 5
    s_add_u32 s26, s26, s25
    buffer_load_ushort v40, v5, s[8:11], s26 offen offset:0
    buffer_load_ushort v41, v5, s[8:11], s26 offen offset:896
    buffer_load_ushort v42, v5, s[8:11], s26 offen offset:1792
    buffer_load_ushort v43, v5, s[8:11], s26 offen offset:2688
    buffer_load_ushort v44, v5, s[8:11], s26 offen offset:3584
    s_add_u32 s27, s26, 4480
    buffer_load_ushort v45, v5, s[8:11], s27 offen
    s_add_u32 s27, s26, 5376
    buffer_load_ushort v46, v5, s[8:11], s27 offen
    s_add_u32 s27, s26, 6272
    buffer_load_ushort v47, v5, s[8:11], s27 offen
P_REP_ST:
    s_waitcnt vmcnt(0)
    v_lshlrev_b32 v6, 4, v2
    s_lshl_b32 s24, s3, 10
    s_add_u32 s24, s24, s22
    v_lshl_or_b32 v48, v17, 16, v16
    v_lshl_or_b32 v49, v19, 16, v18
    v_lshl_or_b32 v50, v21, 16, v20
    v_lshl_or_b32 v51, v23, 16, v22
    buffer_store_dwordx4 v[48:51], v6, s[12:15], s24 offen offset:0
    v_lshl_or_b32 v52, v25, 16, v24
    v_lshl_or_b32 v53, v27, 16, v26
    v_lshl_or_b32 v54, v29, 16, v28
    v_lshl_or_b32 v55, v31, 16, v30
    buffer_store_dwordx4 v[52:55], v6, s[12:15], s24 offen offset:1024
    v_lshl_or_b32 v56, v33, 16, v32
    v_lshl_or_b32 v57, v35, 16, v34
    v_lshl_or_b32 v58, v37, 16, v36
    v_lshl_or_b32 v59, v39, 16, v38
    buffer_store_dwordx4 v[56:59], v6, s[12:15], s24 offen offset:2048
    v_lshl_or_b32 v60, v41, 16, v40
    v_lshl_or_b32 v61, v43, 16, v42
    v_lshl_or_b32 v62, v45, 16, v44
    v_lshl_or_b32 v63, v47, 16, v46
    buffer_store_dwordx4 v[60:63], v6, s[12:15], s24 offen offset:3072
    s_endpgm
P_INIT:
    s_load_dwordx2 s[4:5], s[0:1], 8
    s_sub_u32 s3, s2, 3158
    s_waitcnt lgkmcnt(0)
    s_mov_b32 s12, s6
    s_mov_b32 s13, s7
    s_mov_b32 s14, 268435456
    s_mov_b32 s15, 0x00020000
    s_mov_b32 s8, s4
    s_mov_b32 s9, s5
    s_mov_b32 s10, 7168
    s_mov_b32 s11, 0x00020000
    v_lshlrev_b32 v5, 4, v0
    v_mov_b32 v8, -1
    v_mov_b32 v9, -1
    v_mov_b32 v10, -1
    v_mov_b32 v11, -1
    s_cmp_lt_u32 s3, 28
    s_cbranch_scc1 P_I1
    s_cmp_lt_u32 s3, 76
    s_cbranch_scc1 P_I2
    s_cmp_lt_u32 s3, 80
    s_cbranch_scc1 P_I3
    s_endpgm
P_I1:
    s_lshl_b32 s4, s3, 14
    s_add_u32 s4, s4, 30408704
    s_cmp_eq_u32 s3, 0
    s_cbranch_scc0 P_IF
    v_add_u32 v6, 0, v0
    v_and_b32 v7, 7, v6
    v_mul_u32_u24 v7, 896, v7
    v_lshrrev_b32 v6, 3, v6
    v_lshl_add_u32 v6, v6, 4, v7
    v_mov_b32 v7, 0x10000
    v_cmp_gt_u32 vcc, 448, v0
    s_nop 1
    v_cndmask_b32 v6, v7, v6, vcc
    buffer_load_dwordx4 v[12:15], v6, s[8:11], 0 offen
    v_add_u32 v6, 256, v0
    v_and_b32 v7, 7, v6
    v_mul_u32_u24 v7, 896, v7
    v_lshrrev_b32 v6, 3, v6
    v_lshl_add_u32 v6, v6, 4, v7
    v_mov_b32 v7, 0x10000
    v_cmp_gt_u32 vcc, 192, v0
    s_nop 1
    v_cndmask_b32 v6, v7, v6, vcc
    buffer_load_dwordx4 v[16:19], v6, s[8:11], 0 offen
    v_mov_b32 v20, 0
    v_mov_b32 v21, 0
    v_mov_b32 v22, 0
    v_mov_b32 v23, 0
    v_mov_b32 v24, 0
    v_mov_b32 v25, 0
    v_mov_b32 v26, 0
    v_mov_b32 v27, 0
    s_waitcnt vmcnt(0)
    v_add_u32 v6, 0, v5
    v_cmp_gt_u32 vcc, 7168, v6
    s_nop 1
    v_cndmask_b32 v12, v8, v12, vcc
    v_cndmask_b32 v13, v8, v13, vcc
    v_cndmask_b32 v14, v8, v14, vcc
    v_cndmask_b32 v15, v8, v15, vcc
    buffer_store_dwordx4 v[12:15], v6, s[12:15], s4 offen
    s_add_u32 s5, s4, 524288
    buffer_store_dwordx4 v[12:15], v6, s[12:15], s5 offen
    v_add_u32 v6, 4096, v5
    v_cmp_gt_u32 vcc, 7168, v6
    s_nop 1
    v_cndmask_b32 v16, v8, v16, vcc
    v_cndmask_b32 v17, v8, v17, vcc
    v_cndmask_b32 v18, v8, v18, vcc
    v_cndmask_b32 v19, v8, v19, vcc
    buffer_store_dwordx4 v[16:19], v6, s[12:15], s4 offen
    s_add_u32 s5, s4, 524288
    buffer_store_dwordx4 v[16:19], v6, s[12:15], s5 offen
    v_add_u32 v6, 8192, v5
    v_cmp_gt_u32 vcc, 7168, v6
    s_nop 1
    v_cndmask_b32 v20, v8, v20, vcc
    v_cndmask_b32 v21, v8, v21, vcc
    v_cndmask_b32 v22, v8, v22, vcc
    v_cndmask_b32 v23, v8, v23, vcc
    buffer_store_dwordx4 v[20:23], v6, s[12:15], s4 offen
    v_add_u32 v6, 12288, v5
    v_cmp_gt_u32 vcc, 7168, v6
    s_nop 1
    v_cndmask_b32 v24, v8, v24, vcc
    v_cndmask_b32 v25, v8, v25, vcc
    v_cndmask_b32 v26, v8, v26, vcc
    v_cndmask_b32 v27, v8, v27, vcc
    buffer_store_dwordx4 v[24:27], v6, s[12:15], s4 offen
    s_endpgm
P_I2:
    s_sub_u32 s4, s3, 28
    s_lshl_b32 s4, s4, 14
    s_add_u32 s5, s4, 0
    v_add_u32 v6, s5, v5
    s_mov_b32 s16, 1398102
    v_mul_hi_u32 v7, v6, s16
    v_mul_u32_u24 v7, 3072, v7
    v_sub_u32 v7, v6, v7
    v_cmp_le_u32 vcc, 2048, v7
    v_and_b32 v7, 128, v6
    v_cmp_ne_u32 s[18:19], 0, v7
    s_and_b64 vcc, vcc, s[18:19]
    v_cndmask_b32 v12, -1, 0, vcc
    v_mov_b32 v13, v12
    v_mov_b32 v14, v12
    v_mov_b32 v15, v12
    s_add_u32 s5, s5, 31457280
    buffer_store_dwordx4 v[12:15], v5, s[12:15], s5 offen
    s_nop 1
    s_add_u32 s5, s4, 4096
    v_add_u32 v6, s5, v5
    s_mov_b32 s16, 1398102
    v_mul_hi_u32 v7, v6, s16
    v_mul_u32_u24 v7, 3072, v7
    v_sub_u32 v7, v6, v7
    v_cmp_le_u32 vcc, 2048, v7
    v_and_b32 v7, 128, v6
    v_cmp_ne_u32 s[18:19], 0, v7
    s_and_b64 vcc, vcc, s[18:19]
    v_cndmask_b32 v12, -1, 0, vcc
    v_mov_b32 v13, v12
    v_mov_b32 v14, v12
    v_mov_b32 v15, v12
    s_add_u32 s5, s5, 31457280
    buffer_store_dwordx4 v[12:15], v5, s[12:15], s5 offen
    s_nop 1
    s_add_u32 s5, s4, 8192
    v_add_u32 v6, s5, v5
    s_mov_b32 s16, 1398102
    v_mul_hi_u32 v7, v6, s16
    v_mul_u32_u24 v7, 3072, v7
    v_sub_u32 v7, v6, v7
    v_cmp_le_u32 vcc, 2048, v7
    v_and_b32 v7, 128, v6
    v_cmp_ne_u32 s[18:19], 0, v7
    s_and_b64 vcc, vcc, s[18:19]
    v_cndmask_b32 v12, -1, 0, vcc
    v_mov_b32 v13, v12
    v_mov_b32 v14, v12
    v_mov_b32 v15, v12
    s_add_u32 s5, s5, 31457280
    buffer_store_dwordx4 v[12:15], v5, s[12:15], s5 offen
    s_nop 1
    s_add_u32 s5, s4, 12288
    v_add_u32 v6, s5, v5
    s_mov_b32 s16, 1398102
    v_mul_hi_u32 v7, v6, s16
    v_mul_u32_u24 v7, 3072, v7
    v_sub_u32 v7, v6, v7
    v_cmp_le_u32 vcc, 2048, v7
    v_and_b32 v7, 128, v6
    v_cmp_ne_u32 s[18:19], 0, v7
    s_and_b64 vcc, vcc, s[18:19]
    v_cndmask_b32 v12, -1, 0, vcc
    v_mov_b32 v13, v12
    v_mov_b32 v14, v12
    v_mov_b32 v15, v12
    s_add_u32 s5, s5, 31457280
    buffer_store_dwordx4 v[12:15], v5, s[12:15], s5 offen
    s_nop 1
    s_endpgm
P_I3:
    s_sub_u32 s4, s3, 76
    s_lshl_b32 s4, s4, 14
    s_add_u32 s4, s4, 32505856
    v_mov_b32 v8, 0
    v_mov_b32 v9, 0
    v_mov_b32 v10, 0
    v_mov_b32 v11, 0
P_IF:
    s_add_u32 s5, s4, 0
    buffer_store_dwordx4 v[8:11], v5, s[12:15], s5 offen
    s_add_u32 s5, s4, 4096
    buffer_store_dwordx4 v[8:11], v5, s[12:15], s5 offen
    s_add_u32 s5, s4, 8192
    buffer_store_dwordx4 v[8:11], v5, s[12:15], s5 offen
    s_add_u32 s5, s4, 12288
    buffer_store_dwordx4 v[8:11], v5, s[12:15], s5 offen
    s_endpgm
.p2align 8
.type main_kernel,@function
main_kernel:
    s_cmp_lt_u32 s2, 256
    s_cbranch_scc1 MG_GO
    s_endpgm
MG_GO:
    s_load_dwordx2 s[4:5], s[0:1], 104
    v_lshrrev_b32 v1, 6, v0
    v_and_b32 v2, 63, v0
    v_lshlrev_b32 v3, 4, v2
    v_readfirstlane_b32 s20, v1
    s_waitcnt lgkmcnt(0)
    s_mov_b32 s8, s4
    s_mov_b32 s9, s5
    s_mov_b32 s10, 268435456
    s_mov_b32 s11, 0x00020000
    s_getreg_b32 s40, hwreg(HW_REG_XCC_ID)
    s_and_b32 s40, s40, 7
    v_mov_b32 v4, 0
    v_mov_b32 v5, 1
    s_cmp_eq_u32 s20, 0
    s_cbranch_scc0 MG_WAITROLE
    s_mov_b64 exec, 1
    s_lshl_b32 s41, s40, 7
    s_add_u32 s41, s41, 32546816
    buffer_atomic_add v5, v4, s[8:11], s41 offen sc0
    v_mov_b32 v6, 1
    s_mov_b32 s42, 32547840
    buffer_atomic_add v6, v4, s[8:11], s42 offen
    s_waitcnt vmcnt(0)
    v_readfirstlane_b32 s43, v5
    s_nop 3
    s_cmp_eq_u32 s40, 0
    s_cbranch_scc0 MG_OTHER
    s_cmp_lt_u32 s43, 30
    s_cbranch_scc1 MG_PUB
    s_cmp_lt_u32 s43, 32
    s_cbranch_scc0 MG_OTHER
    s_add_u32 s43, s43, 970
    s_branch MG_PUB
MG_OTHER:
    v_mov_b32 v5, 1
    s_mov_b32 s42, 32547968
    buffer_atomic_add v5, v4, s[8:11], s42 offen sc0
    s_waitcnt vmcnt(0)
    v_readfirstlane_b32 s43, v5
    s_nop 3
    s_add_u32 s43, s43, 30
MG_PUB:
    v_mov_b32 v5, s43
    ds_write_b32 v4, v5
    s_waitcnt lgkmcnt(0)
    s_mov_b64 exec, -1
MG_WAITROLE:
    s_barrier
    v_mov_b32 v4, 0
    ds_read_b32 v5, v4
    s_waitcnt lgkmcnt(0)
    v_readfirstlane_b32 s43, v5
    s_barrier
    s_mov_b32 s48, 0
    s_sub_u32 s21, s43, 1000
    s_cmp_ge_u32 s43, 1000
    s_cbranch_scc1 ROLE_HELP
    s_cmp_lt_u32 s43, 30
    s_cbranch_scc1 MG_CHAIN
    s_sub_u32 s44, s43, 30
    s_cmp_lt_u32 s44, 48
    s_cbranch_scc0 MR_1
    s_sub_u32 s44, s44, 0
    s_mul_i32 s22, s44, 4097
    s_lshr_b32 s22, s22, 16
    s_mul_i32 s21, s22, 16
    s_sub_u32 s21, s44, s21
    s_mov_b32 s23, 3
    s_branch ROLE_W1
MR_1:
    s_cmp_lt_u32 s44, 112
    s_cbranch_scc0 MR_2
    s_sub_u32 s44, s44, 48
    s_mul_i32 s22, s44, 4097
    s_lshr_b32 s22, s22, 16
    s_mul_i32 s21, s22, 16
    s_sub_u32 s21, s44, s21
    s_mov_b32 s23, 4
    s_branch ROLE_W2
MR_2:
    s_cmp_lt_u32 s44, 154
    s_cbranch_scc0 MR_3
    s_sub_u32 s44, s44, 112
    s_mul_i32 s22, s44, 4682
    s_lshr_b32 s22, s22, 16
    s_mul_i32 s21, s22, 14
    s_sub_u32 s21, s44, s21
    s_mov_b32 s23, 3
    s_branch ROLE_W4
MR_3:
    s_cmp_lt_u32 s44, 182
    s_cbranch_scc0 MR_4
    s_sub_u32 s44, s44, 154
    s_mul_i32 s22, s44, 9363
    s_lshr_b32 s22, s22, 16
    s_mul_i32 s21, s22, 7
    s_sub_u32 s21, s44, s21
    s_mov_b32 s23, 4
    s_branch ROLE_W3
MR_4:
    s_cmp_lt_u32 s44, 194
    s_cbranch_scc0 MR_5
    s_sub_u32 s44, s44, 182
    s_mul_i32 s22, s44, 16385
    s_lshr_b32 s22, s22, 16
    s_mul_i32 s21, s22, 4
    s_sub_u32 s21, s44, s21
    s_mov_b32 s23, 3
    s_branch ROLE_W5
MR_5:
    v_mov_b32 v4, 0
    s_mov_b32 s34, 0
MG_SB:
    s_mov_b32 s42, 32547840
    buffer_load_dword v5, v4, s[8:11], s42 offen sc1
    s_mov_b32 s42, 32546816
    buffer_load_dword v6, v4, s[8:11], s42 offen sc1
    s_add_u32 s34, s34, 1
    s_cmp_gt_u32 s34, 4194304
    s_cbranch_scc1 MG_EXIT
    s_waitcnt vmcnt(0)
    v_readfirstlane_b32 s45, v5
    v_readfirstlane_b32 s46, v6
    s_nop 3
    s_cmp_lt_u32 s45, 256
    s_cbranch_scc1 MG_SB
    buffer_load_dword v6, v4, s[8:11], s42 offen sc1
    s_waitcnt vmcnt(0)
    v_readfirstlane_b32 s46, v6
    s_nop 3
    s_cmp_lt_u32 s46, 30
    s_cbranch_scc0 MG_EXIT
    s_sub_u32 s43, s44, 194
    s_add_u32 s43, s43, s46
    s_cmp_lt_u32 s43, 30
    s_cbranch_scc0 MG_EXIT
    s_mov_b32 s48, 1
    s_branch MG_CH2
MG_EXIT:
    s_endpgm
MG_CHAIN:
    s_mov_b32 s48, 2
MG_CH2:
    s_mov_b32 s21, s43
    s_cmp_lt_u32 s43, 16
    s_cbranch_scc1 ROLE_SCORE
    s_sub_u32 s21, s43, 16
    s_branch ROLE_VALUE
ROLE_W1:
    s_mul_i32 s24, s21, 28
    s_mul_i32 s25, s20, 7
    s_add_u32 s24, s24, s25
    s_mul_i32 s24, s24, 14336
    s_add_u32 s24, s24, 16777216
    s_mul_i32 s26, s20, 7168
    s_mul_i32 s27, s22, 28672
    s_add_u32 s27, s27, s26
    s_mov_b32 m0, s26
    s_nop 0
    buffer_load_dwordx4 v3, s[8:11], s27 offen offset:0  lds
    buffer_load_dwordx4 v3, s[8:11], s27 offen offset:1024  lds
    buffer_load_dwordx4 v3, s[8:11], s27 offen offset:2048  lds
    buffer_load_dwordx4 v3, s[8:11], s27 offen offset:3072  lds
    s_add_u32 s28, s26, 4096
    s_add_u32 s29, s27, 4096
    s_mov_b32 m0, s28
    s_nop 0
    buffer_load_dwordx4 v3, s[8:11], s29 offen offset:0  lds
    buffer_load_dwordx4 v3, s[8:11], s29 offen offset:1024  lds
    buffer_load_dwordx4 v3, s[8:11], s29 offen offset:2048  lds
    s_add_u32 s25, s24, 0
    buffer_load_dwordx4 a[0:3], v3, s[8:11], s25 offen offset:0
    buffer_load_dwordx4 a[4:7], v3, s[8:11], s25 offen offset:1024
    buffer_load_dwordx4 a[8:11], v3, s[8:11], s25 offen offset:2048
    buffer_load_dwordx4 a[12:15], v3, s[8:11], s25 offen offset:3072
    s_add_u32 s25, s24, 4096
    buffer_load_dwordx4 a[16:19], v3, s[8:11], s25 offen offset:0
    buffer_load_dwordx4 a[20:23], v3, s[8:11], s25 offen offset:1024
    buffer_load_dwordx4 a[24:27], v3, s[8:11], s25 offen offset:2048
    buffer_load_dwordx4 a[28:31], v3, s[8:11], s25 offen offset:3072
    s_add_u32 s25, s24, 8192
    buffer_load_dwordx4 a[32:35], v3, s[8:11], s25 offen offset:0
    buffer_load_dwordx4 a[36:39], v3, s[8:11], s25 offen offset:1024
    buffer_load_dwordx4 a[40:43], v3, s[8:11], s25 offen offset:2048
    buffer_load_dwordx4 a[44:47], v3, s[8:11], s25 offen offset:3072
    s_add_u32 s25, s24, 12288
    buffer_load_dwordx4 a[48:51], v3, s[8:11], s25 offen offset:0
    buffer_load_dwordx4 a[52:55], v3, s[8:11], s25 offen offset:1024
    buffer_load_dwordx4 a[56:59], v3, s[8:11], s25 offen offset:2048
    buffer_load_dwordx4 a[60:63], v3, s[8:11], s25 offen offset:3072
    s_add_u32 s25, s24, 16384
    buffer_load_dwordx4 a[64:67], v3, s[8:11], s25 offen offset:0
    buffer_load_dwordx4 a[68:71], v3, s[8:11], s25 offen offset:1024
    buffer_load_dwordx4 a[72:75], v3, s[8:11], s25 offen offset:2048
    buffer_load_dwordx4 a[76:79], v3, s[8:11], s25 offen offset:3072
    s_add_u32 s25, s24, 20480
    buffer_load_dwordx4 a[80:83], v3, s[8:11], s25 offen offset:0
    buffer_load_dwordx4 a[84:87], v3, s[8:11], s25 offen offset:1024
    buffer_load_dwordx4 a[88:91], v3, s[8:11], s25 offen offset:2048
    buffer_load_dwordx4 a[92:95], v3, s[8:11], s25 offen offset:3072
    s_add_u32 s25, s24, 24576
    buffer_load_dwordx4 a[96:99], v3, s[8:11], s25 offen offset:0
    buffer_load_dwordx4 a[100:103], v3, s[8:11], s25 offen offset:1024
    buffer_load_dwordx4 a[104:107], v3, s[8:11], s25 offen offset:2048
    buffer_load_dwordx4 a[108:111], v3, s[8:11], s25 offen offset:3072
    s_add_u32 s25, s24, 28672
    buffer_load_dwordx4 a[112:115], v3, s[8:11], s25 offen offset:0
    buffer_load_dwordx4 a[116:119], v3, s[8:11], s25 offen offset:1024
    buffer_load_dwordx4 a[120:123], v3, s[8:11], s25 offen offset:2048
    buffer_load_dwordx4 a[124:127], v3, s[8:11], s25 offen offset:3072
    s_add_u32 s25, s24, 32768
    buffer_load_dwordx4 a[128:131], v3, s[8:11], s25 offen offset:0
    buffer_load_dwordx4 a[132:135], v3, s[8:11], s25 offen offset:1024
    buffer_load_dwordx4 a[136:139], v3, s[8:11], s25 offen offset:2048
    buffer_load_dwordx4 a[140:143], v3, s[8:11], s25 offen offset:3072
    s_add_u32 s25, s24, 36864
    buffer_load_dwordx4 a[144:147], v3, s[8:11], s25 offen offset:0
    buffer_load_dwordx4 a[148:151], v3, s[8:11], s25 offen offset:1024
    buffer_load_dwordx4 a[152:155], v3, s[8:11], s25 offen offset:2048
    buffer_load_dwordx4 a[156:159], v3, s[8:11], s25 offen offset:3072
    s_add_u32 s25, s24, 40960
    buffer_load_dwordx4 a[160:163], v3, s[8:11], s25 offen offset:0
    buffer_load_dwordx4 a[164:167], v3, s[8:11], s25 offen offset:1024
    buffer_load_dwordx4 a[168:171], v3, s[8:11], s25 offen offset:2048
    buffer_load_dwordx4 a[172:175], v3, s[8:11], s25 offen offset:3072
    s_add_u32 s25, s24, 45056
    buffer_load_dwordx4 a[176:179], v3, s[8:11], s25 offen offset:0
    buffer_load_dwordx4 a[180:183], v3, s[8:11], s25 offen offset:1024
    buffer_load_dwordx4 a[184:187], v3, s[8:11], s25 offen offset:2048
    buffer_load_dwordx4 a[188:191], v3, s[8:11], s25 offen offset:3072
    s_add_u32 s25, s24, 49152
    buffer_load_dwordx4 a[192:195], v3, s[8:11], s25 offen offset:0
    buffer_load_dwordx4 a[196:199], v3, s[8:11], s25 offen offset:1024
    buffer_load_dwordx4 a[200:203], v3, s[8:11], s25 offen offset:2048
    buffer_load_dwordx4 a[204:207], v3, s[8:11], s25 offen offset:3072
    s_add_u32 s25, s24, 53248
    buffer_load_dwordx4 a[208:211], v3, s[8:11], s25 offen offset:0
    buffer_load_dwordx4 a[212:215], v3, s[8:11], s25 offen offset:1024
    buffer_load_dwordx4 a[216:219], v3, s[8:11], s25 offen offset:2048
    buffer_load_dwordx4 a[220:223], v3, s[8:11], s25 offen offset:3072
    s_add_u32 s25, s24, 57344
    buffer_load_dwordx4 a[224:227], v3, s[8:11], s25 offen offset:0
    buffer_load_dwordx4 a[228:231], v3, s[8:11], s25 offen offset:1024
    buffer_load_dwordx4 a[232:235], v3, s[8:11], s25 offen offset:2048
    buffer_load_dwordx4 a[236:239], v3, s[8:11], s25 offen offset:3072
    s_add_u32 s25, s24, 61440
    buffer_load_dwordx4 a[240:243], v3, s[8:11], s25 offen offset:0
    buffer_load_dwordx4 a[244:247], v3, s[8:11], s25 offen offset:1024
    buffer_load_dwordx4 a[248:251], v3, s[8:11], s25 offen offset:2048
    buffer_load_dwordx4 a[252:255], v3, s[8:11], s25 offen offset:3072
    s_add_u32 s25, s24, 65536
    buffer_load_dwordx4 v[120:123], v3, s[8:11], s25 offen offset:0
    buffer_load_dwordx4 v[124:127], v3, s[8:11], s25 offen offset:1024
    buffer_load_dwordx4 v[128:131], v3, s[8:11], s25 offen offset:2048
    buffer_load_dwordx4 v[132:135], v3, s[8:11], s25 offen offset:3072
    s_add_u32 s25, s24, 69632
    buffer_load_dwordx4 v[136:139], v3, s[8:11], s25 offen offset:0
    buffer_load_dwordx4 v[140:143], v3, s[8:11], s25 offen offset:1024
    buffer_load_dwordx4 v[144:147], v3, s[8:11], s25 offen offset:2048
    buffer_load_dwordx4 v[148:151], v3, s[8:11], s25 offen offset:3072
    s_add_u32 s25, s24, 73728
    buffer_load_dwordx4 v[152:155], v3, s[8:11], s25 offen offset:0
    buffer_load_dwordx4 v[156:159], v3, s[8:11], s25 offen offset:1024
    buffer_load_dwordx4 v[160:163], v3, s[8:11], s25 offen offset:2048
    buffer_load_dwordx4 v[164:167], v3, s[8:11], s25 offen offset:3072
    s_add_u32 s25, s24, 77824
    buffer_load_dwordx4 v[168:171], v3, s[8:11], s25 offen offset:0
    buffer_load_dwordx4 v[172:175], v3, s[8:11], s25 offen offset:1024
    buffer_load_dwordx4 v[176:179], v3, s[8:11], s25 offen offset:2048
    buffer_load_dwordx4 v[180:183], v3, s[8:11], s25 offen offset:3072
    s_add_u32 s25, s24, 81920
    buffer_load_dwordx4 v[184:187], v3, s[8:11], s25 offen offset:0
    buffer_load_dwordx4 v[188:191], v3, s[8:11], s25 offen offset:1024
    buffer_load_dwordx4 v[192:195], v3, s[8:11], s25 offen offset:2048
    buffer_load_dwordx4 v[196:199], v3, s[8:11], s25 offen offset:3072
    s_add_u32 s25, s24, 86016
    buffer_load_dwordx4 v[200:203], v3, s[8:11], s25 offen offset:0
    buffer_load_dwordx4 v[204:207], v3, s[8:11], s25 offen offset:1024
    buffer_load_dwordx4 v[208:211], v3, s[8:11], s25 offen offset:2048
    buffer_load_dwordx4 v[212:215], v3, s[8:11], s25 offen offset:3072
    s_add_u32 s25, s24, 90112
    buffer_load_dwordx4 v[216:219], v3, s[8:11], s25 offen offset:0
    buffer_load_dwordx4 v[220:223], v3, s[8:11], s25 offen offset:1024
    buffer_load_dwordx4 v[224:227], v3, s[8:11], s25 offen offset:2048
    buffer_load_dwordx4 v[228:231], v3, s[8:11], s25 offen offset:3072
    s_add_u32 s25, s24, 94208
    buffer_load_dwordx4 v[232:235], v3, s[8:11], s25 offen offset:0
    buffer_load_dwordx4 v[236:239], v3, s[8:11], s25 offen offset:1024
    buffer_load_dwordx4 v[240:243], v3, s[8:11], s25 offen offset:2048
    buffer_load_dwordx4 v[244:247], v3, s[8:11], s25 offen offset:3072
    s_add_u32 s25, s24, 98304
    buffer_load_dwordx4 v[248:251], v3, s[8:11], s25 offen offset:0
    buffer_load_dwordx4 v[252:255], v3, s[8:11], s25 offen offset:1024
    v_and_b32 v4, 15, v2
    v_lshrrev_b32 v5, 4, v2
    v_lshrrev_b32 v6, 1, v5
    v_mul_u32_u24 v6, 7168, v6
    v_lshl_add_u32 v6, v4, 4, v6
    v_and_b32 v5, 1, v5
    v_lshl_add_u32 v6, v5, 3, v6
    v_mov_b32 v7, 1
    v_mov_b32 v8, 0
    s_mov_b32 s30, 0
    s_waitcnt vmcnt(0)
    s_barrier
W1_LOOP:
    s_add_u32 s31, s22, s23
    s_cmp_lt_u32 s31, 64
    s_cbranch_scc0 W1_NOPF
    s_mul_i32 s27, s31, 28672
    s_add_u32 s27, s27, s26
    s_sub_u32 s32, 28672, s30
    s_add_u32 s32, s32, s26
    s_mov_b32 m0, s32
    s_nop 0
    buffer_load_dwordx4 v3, s[8:11], s27 offen offset:0  lds
    buffer_load_dwordx4 v3, s[8:11], s27 offen offset:1024  lds
    buffer_load_dwordx4 v3, s[8:11], s27 offen offset:2048  lds
    buffer_load_dwordx4 v3, s[8:11], s27 offen offset:3072  lds
    s_add_u32 s28, s32, 4096
    s_add_u32 s29, s27, 4096
    s_mov_b32 m0, s28
    s_nop 0
    buffer_load_dwordx4 v3, s[8:11], s29 offen offset:0  lds
    buffer_load_dwordx4 v3, s[8:11], s29 offen offset:1024  lds
    buffer_load_dwordx4 v3, s[8:11], s29 offen offset:2048  lds
W1_NOPF:
    v_add_u32 v9, s30, v3
    ds_read_b128 v[16:19], v9 offset:0
    ds_read_b128 v[20:23], v9 offset:1024
    ds_read_b128 v[24:27], v9 offset:2048
    ds_read_b128 v[28:31], v9 offset:3072
    s_waitcnt lgkmcnt(2)
    v_mfma_f32_16x16x32_bf16 v[32:35], v[16:19], a[0:3], 0
    v_mfma_f32_16x16x32_bf16 v[36:39], v[20:23], a[0:3], 0
    v_mfma_f32_16x16x32_bf16 v[40:43], v[16:19], a[56:59], 0
    v_mfma_f32_16x16x32_bf16 v[44:47], v[20:23], a[56:59], 0
    v_mfma_f32_16x16x32_bf16 v[48:51], v[16:19], a[112:115], 0
    v_mfma_f32_16x16x32_bf16 v[52:55], v[20:23], a[112:115], 0
    v_mfma_f32_16x16x32_bf16 v[56:59], v[16:19], a[168:171], 0
    v_mfma_f32_16x16x32_bf16 v[60:63], v[20:23], a[168:171], 0
    v_mfma_f32_16x16x32_bf16 v[64:67], v[16:19], a[224:227], 0
    v_mfma_f32_16x16x32_bf16 v[68:71], v[20:23], a[224:227], 0
    v_mfma_f32_16x16x32_bf16 v[72:75], v[16:19], v[144:147], 0
    v_mfma_f32_16x16x32_bf16 v[76:79], v[20:23], v[144:147], 0
    v_mfma_f32_16x16x32_bf16 v[80:83], v[16:19], v[200:203], 0
    v_mfma_f32_16x16x32_bf16 v[84:87], v[20:23], v[200:203], 0
    ds_read_b128 v[16:19], v9 offset:4096
    ds_read_b128 v[20:23], v9 offset:5120
    s_waitcnt lgkmcnt(2)
    v_mfma_f32_16x16x32_bf16 v[32:35], v[24:27], a[4:7], v[32:35]
    v_mfma_f32_16x16x32_bf16 v[36:39], v[28:31], a[4:7], v[36:39]
    v_mfma_f32_16x16x32_bf16 v[40:43], v[24:27], a[60:63], v[40:43]
    v_mfma_f32_16x16x32_bf16 v[44:47], v[28:31], a[60:63], v[44:47]
    v_mfma_f32_16x16x32_bf16 v[48:51], v[24:27], a[116:119], v[48:51]
    v_mfma_f32_16x16x32_bf16 v[52:55], v[28:31], a[116:119], v[52:55]
    v_mfma_f32_16x16x32_bf16 v[56:59], v[24:27], a[172:175], v[56:59]
    v_mfma_f32_16x16x32_bf16 v[60:63], v[28:31], a[172:175], v[60:63]
    v_mfma_f32_16x16x32_bf16 v[64:67], v[24:27], a[228:231], v[64:67]
    v_mfma_f32_16x16x32_bf16 v[68:71], v[28:31], a[228:231], v[68:71]
    v_mfma_f32_16x16x32_bf16 v[72:75], v[24:27], v[148:151], v[72:75]
    v_mfma_f32_16x16x32_bf16 v[76:79], v[28:31], v[148:151], v[76:79]
    v_mfma_f32_16x16x32_bf16 v[80:83], v[24:27], v[204:207], v[80:83]
    v_mfma_f32_16x16x32_bf16 v[84:87], v[28:31], v[204:207], v[84:87]
    ds_read_b128 v[24:27], v9 offset:6144
    ds_read_b128 v[28:31], v9 offset:7168
    s_waitcnt lgkmcnt(2)
    v_mfma_f32_16x16x32_bf16 v[32:35], v[16:19], a[8:11], v[32:35]
    v_mfma_f32_16x16x32_bf16 v[36:39], v[20:23], a[8:11], v[36:39]
    v_mfma_f32_16x16x32_bf16 v[40:43], v[16:19], a[64:67], v[40:43]
    v_mfma_f32_16x16x32_bf16 v[44:47], v[20:23], a[64:67], v[44:47]
    v_mfma_f32_16x16x32_bf16 v[48:51], v[16:19], a[120:123], v[48:51]
    v_mfma_f32_16x16x32_bf16 v[52:55], v[20:23], a[120:123], v[52:55]
    v_mfma_f32_16x16x32_bf16 v[56:59], v[16:19], a[176:179], v[56:59]
    v_mfma_f32_16x16x32_bf16 v[60:63], v[20:23], a[176:179], v[60:63]
    v_mfma_f32_16x16x32_bf16 v[64:67], v[16:19], a[232:235], v[64:67]
    v_mfma_f32_16x16x32_bf16 v[68:71], v[20:23], a[232:235], v[68:71]
    v_mfma_f32_16x16x32_bf16 v[72:75], v[16:19], v[152:155], v[72:75]
    v_mfma_f32_16x16x32_bf16 v[76:79], v[20:23], v[152:155], v[76:79]
    v_mfma_f32_16x16x32_bf16 v[80:83], v[16:19], v[208:211], v[80:83]
    v_mfma_f32_16x16x32_bf16 v[84:87], v[20:23], v[208:211], v[84:87]
    ds_read_b128 v[16:19], v9 offset:8192
    ds_read_b128 v[20:23], v9 offset:9216
    s_waitcnt lgkmcnt(2)
    v_mfma_f32_16x16x32_bf16 v[32:35], v[24:27], a[12:15], v[32:35]
    v_mfma_f32_16x16x32_bf16 v[36:39], v[28:31], a[12:15], v[36:39]
    v_mfma_f32_16x16x32_bf16 v[40:43], v[24:27], a[68:71], v[40:43]
    v_mfma_f32_16x16x32_bf16 v[44:47], v[28:31], a[68:71], v[44:47]
    v_mfma_f32_16x16x32_bf16 v[48:51], v[24:27], a[124:127], v[48:51]
    v_mfma_f32_16x16x32_bf16 v[52:55], v[28:31], a[124:127], v[52:55]
    v_mfma_f32_16x16x32_bf16 v[56:59], v[24:27], a[180:183], v[56:59]
    v_mfma_f32_16x16x32_bf16 v[60:63], v[28:31], a[180:183], v[60:63]
    v_mfma_f32_16x16x32_bf16 v[64:67], v[24:27], a[236:239], v[64:67]
    v_mfma_f32_16x16x32_bf16 v[68:71], v[28:31], a[236:239], v[68:71]
    v_mfma_f32_16x16x32_bf16 v[72:75], v[24:27], v[156:159], v[72:75]
    v_mfma_f32_16x16x32_bf16 v[76:79], v[28:31], v[156:159], v[76:79]
    v_mfma_f32_16x16x32_bf16 v[80:83], v[24:27], v[212:215], v[80:83]
    v_mfma_f32_16x16x32_bf16 v[84:87], v[28:31], v[212:215], v[84:87]
    ds_read_b128 v[24:27], v9 offset:10240
    ds_read_b128 v[28:31], v9 offset:11264
    s_waitcnt lgkmcnt(2)
    v_mfma_f32_16x16x32_bf16 v[32:35], v[16:19], a[16:19], v[32:35]
    v_mfma_f32_16x16x32_bf16 v[36:39], v[20:23], a[16:19], v[36:39]
    v_mfma_f32_16x16x32_bf16 v[40:43], v[16:19], a[72:75], v[40:43]
    v_mfma_f32_16x16x32_bf16 v[44:47], v[20:23], a[72:75], v[44:47]
    v_mfma_f32_16x16x32_bf16 v[48:51], v[16:19], a[128:131], v[48:51]
    v_mfma_f32_16x16x32_bf16 v[52:55], v[20:23], a[128:131], v[52:55]
    v_mfma_f32_16x16x32_bf16 v[56:59], v[16:19], a[184:187], v[56:59]
    v_mfma_f32_16x16x32_bf16 v[60:63], v[20:23], a[184:187], v[60:63]
    v_mfma_f32_16x16x32_bf16 v[64:67], v[16:19], a[240:243], v[64:67]
    v_mfma_f32_16x16x32_bf16 v[68:71], v[20:23], a[240:243], v[68:71]
    v_mfma_f32_16x16x32_bf16 v[72:75], v[16:19], v[160:163], v[72:75]
    v_mfma_f32_16x16x32_bf16 v[76:79], v[20:23], v[160:163], v[76:79]
    v_mfma_f32_16x16x32_bf16 v[80:83], v[16:19], v[216:219], v[80:83]
    v_mfma_f32_16x16x32_bf16 v[84:87], v[20:23], v[216:219], v[84:87]
    ds_read_b128 v[16:19], v9 offset:12288
    ds_read_b128 v[20:23], v9 offset:13312
    s_waitcnt lgkmcnt(2)
    v_mfma_f32_16x16x32_bf16 v[32:35], v[24:27], a[20:23], v[32:35]
    v_mfma_f32_16x16x32_bf16 v[36:39], v[28:31], a[20:23], v[36:39]
    v_mfma_f32_16x16x32_bf16 v[40:43], v[24:27], a[76:79], v[40:43]
    v_mfma_f32_16x16x32_bf16 v[44:47], v[28:31], a[76:79], v[44:47]
    v_mfma_f32_16x16x32_bf16 v[48:51], v[24:27], a[132:135], v[48:51]
    v_mfma_f32_16x16x32_bf16 v[52:55], v[28:31], a[132:135], v[52:55]
    v_mfma_f32_16x16x32_bf16 v[56:59], v[24:27], a[188:191], v[56:59]
    v_mfma_f32_16x16x32_bf16 v[60:63], v[28:31], a[188:191], v[60:63]
    v_mfma_f32_16x16x32_bf16 v[64:67], v[24:27], a[244:247], v[64:67]
    v_mfma_f32_16x16x32_bf16 v[68:71], v[28:31], a[244:247], v[68:71]
    v_mfma_f32_16x16x32_bf16 v[72:75], v[24:27], v[164:167], v[72:75]
    v_mfma_f32_16x16x32_bf16 v[76:79], v[28:31], v[164:167], v[76:79]
    v_mfma_f32_16x16x32_bf16 v[80:83], v[24:27], v[220:223], v[80:83]
    v_mfma_f32_16x16x32_bf16 v[84:87], v[28:31], v[220:223], v[84:87]
    ds_read_b128 v[24:27], v9 offset:14336
    ds_read_b128 v[28:31], v9 offset:15360
    s_waitcnt lgkmcnt(2)
    v_mfma_f32_16x16x32_bf16 v[32:35], v[16:19], a[24:27], v[32:35]
    v_mfma_f32_16x16x32_bf16 v[36:39], v[20:23], a[24:27], v[36:39]
    v_mfma_f32_16x16x32_bf16 v[40:43], v[16:19], a[80:83], v[40:43]
    v_mfma_f32_16x16x32_bf16 v[44:47], v[20:23], a[80:83], v[44:47]
    v_mfma_f32_16x16x32_bf16 v[48:51], v[16:19], a[136:139], v[48:51]
    v_mfma_f32_16x16x32_bf16 v[52:55], v[20:23], a[136:139], v[52:55]
    v_mfma_f32_16x16x32_bf16 v[56:59], v[16:19], a[192:195], v[56:59]
    v_mfma_f32_16x16x32_bf16 v[60:63], v[20:23], a[192:195], v[60:63]
    v_mfma_f32_16x16x32_bf16 v[64:67], v[16:19], a[248:251], v[64:67]
    v_mfma_f32_16x16x32_bf16 v[68:71], v[20:23], a[248:251], v[68:71]
    v_mfma_f32_16x16x32_bf16 v[72:75], v[16:19], v[168:171], v[72:75]
    v_mfma_f32_16x16x32_bf16 v[76:79], v[20:23], v[168:171], v[76:79]
    v_mfma_f32_16x16x32_bf16 v[80:83], v[16:19], v[224:227], v[80:83]
    v_mfma_f32_16x16x32_bf16 v[84:87], v[20:23], v[224:227], v[84:87]
    ds_read_b128 v[16:19], v9 offset:16384
    ds_read_b128 v[20:23], v9 offset:17408
    s_waitcnt lgkmcnt(2)
    v_mfma_f32_16x16x32_bf16 v[32:35], v[24:27], a[28:31], v[32:35]
    v_mfma_f32_16x16x32_bf16 v[36:39], v[28:31], a[28:31], v[36:39]
    v_mfma_f32_16x16x32_bf16 v[40:43], v[24:27], a[84:87], v[40:43]
    v_mfma_f32_16x16x32_bf16 v[44:47], v[28:31], a[84:87], v[44:47]
    v_mfma_f32_16x16x32_bf16 v[48:51], v[24:27], a[140:143], v[48:51]
    v_mfma_f32_16x16x32_bf16 v[52:55], v[28:31], a[140:143], v[52:55]
    v_mfma_f32_16x16x32_bf16 v[56:59], v[24:27], a[196:199], v[56:59]
    v_mfma_f32_16x16x32_bf16 v[60:63], v[28:31], a[196:199], v[60:63]
    v_mfma_f32_16x16x32_bf16 v[64:67], v[24:27], a[252:255], v[64:67]
    v_mfma_f32_16x16x32_bf16 v[68:71], v[28:31], a[252:255], v[68:71]
    v_mfma_f32_16x16x32_bf16 v[72:75], v[24:27], v[172:175], v[72:75]
    v_mfma_f32_16x16x32_bf16 v[76:79], v[28:31], v[172:175], v[76:79]
    v_mfma_f32_16x16x32_bf16 v[80:83], v[24:27], v[228:231], v[80:83]
    v_mfma_f32_16x16x32_bf16 v[84:87], v[28:31], v[228:231], v[84:87]
    ds_read_b128 v[24:27], v9 offset:18432
    ds_read_b128 v[28:31], v9 offset:19456
    s_waitcnt lgkmcnt(2)
    v_mfma_f32_16x16x32_bf16 v[32:35], v[16:19], a[32:35], v[32:35]
    v_mfma_f32_16x16x32_bf16 v[36:39], v[20:23], a[32:35], v[36:39]
    v_mfma_f32_16x16x32_bf16 v[40:43], v[16:19], a[88:91], v[40:43]
    v_mfma_f32_16x16x32_bf16 v[44:47], v[20:23], a[88:91], v[44:47]
    v_mfma_f32_16x16x32_bf16 v[48:51], v[16:19], a[144:147], v[48:51]
    v_mfma_f32_16x16x32_bf16 v[52:55], v[20:23], a[144:147], v[52:55]
    v_mfma_f32_16x16x32_bf16 v[56:59], v[16:19], a[200:203], v[56:59]
    v_mfma_f32_16x16x32_bf16 v[60:63], v[20:23], a[200:203], v[60:63]
    v_mfma_f32_16x16x32_bf16 v[64:67], v[16:19], v[120:123], v[64:67]
    v_mfma_f32_16x16x32_bf16 v[68:71], v[20:23], v[120:123], v[68:71]
    v_mfma_f32_16x16x32_bf16 v[72:75], v[16:19], v[176:179], v[72:75]
    v_mfma_f32_16x16x32_bf16 v[76:79], v[20:23], v[176:179], v[76:79]
    v_mfma_f32_16x16x32_bf16 v[80:83], v[16:19], v[232:235], v[80:83]
    v_mfma_f32_16x16x32_bf16 v[84:87], v[20:23], v[232:235], v[84:87]
    ds_read_b128 v[16:19], v9 offset:20480
    ds_read_b128 v[20:23], v9 offset:21504
    s_waitcnt lgkmcnt(2)
    v_mfma_f32_16x16x32_bf16 v[32:35], v[24:27], a[36:39], v[32:35]
    v_mfma_f32_16x16x32_bf16 v[36:39], v[28:31], a[36:39], v[36:39]
    v_mfma_f32_16x16x32_bf16 v[40:43], v[24:27], a[92:95], v[40:43]
    v_mfma_f32_16x16x32_bf16 v[44:47], v[28:31], a[92:95], v[44:47]
    v_mfma_f32_16x16x32_bf16 v[48:51], v[24:27], a[148:151], v[48:51]
    v_mfma_f32_16x16x32_bf16 v[52:55], v[28:31], a[148:151], v[52:55]
    v_mfma_f32_16x16x32_bf16 v[56:59], v[24:27], a[204:207], v[56:59]
    v_mfma_f32_16x16x32_bf16 v[60:63], v[28:31], a[204:207], v[60:63]
    v_mfma_f32_16x16x32_bf16 v[64:67], v[24:27], v[124:127], v[64:67]
    v_mfma_f32_16x16x32_bf16 v[68:71], v[28:31], v[124:127], v[68:71]
    v_mfma_f32_16x16x32_bf16 v[72:75], v[24:27], v[180:183], v[72:75]
    v_mfma_f32_16x16x32_bf16 v[76:79], v[28:31], v[180:183], v[76:79]
    v_mfma_f32_16x16x32_bf16 v[80:83], v[24:27], v[236:239], v[80:83]
    v_mfma_f32_16x16x32_bf16 v[84:87], v[28:31], v[236:239], v[84:87]
    ds_read_b128 v[24:27], v9 offset:22528
    ds_read_b128 v[28:31], v9 offset:23552
    s_waitcnt lgkmcnt(2)
    v_mfma_f32_16x16x32_bf16 v[32:35], v[16:19], a[40:43], v[32:35]
    v_mfma_f32_16x16x32_bf16 v[36:39], v[20:23], a[40:43], v[36:39]
    v_mfma_f32_16x16x32_bf16 v[40:43], v[16:19], a[96:99], v[40:43]
    v_mfma_f32_16x16x32_bf16 v[44:47], v[20:23], a[96:99], v[44:47]
    v_mfma_f32_16x16x32_bf16 v[48:51], v[16:19], a[152:155], v[48:51]
    v_mfma_f32_16x16x32_bf16 v[52:55], v[20:23], a[152:155], v[52:55]
    v_mfma_f32_16x16x32_bf16 v[56:59], v[16:19], a[208:211], v[56:59]
    v_mfma_f32_16x16x32_bf16 v[60:63], v[20:23], a[208:211], v[60:63]
    v_mfma_f32_16x16x32_bf16 v[64:67], v[16:19], v[128:131], v[64:67]
    v_mfma_f32_16x16x32_bf16 v[68:71], v[20:23], v[128:131], v[68:71]
    v_mfma_f32_16x16x32_bf16 v[72:75], v[16:19], v[184:187], v[72:75]
    v_mfma_f32_16x16x32_bf16 v[76:79], v[20:23], v[184:187], v[76:79]
    v_mfma_f32_16x16x32_bf16 v[80:83], v[16:19], v[240:243], v[80:83]
    v_mfma_f32_16x16x32_bf16 v[84:87], v[20:23], v[240:243], v[84:87]
    ds_read_b128 v[16:19], v9 offset:24576
    ds_read_b128 v[20:23], v9 offset:25600
    s_waitcnt lgkmcnt(2)
    v_mfma_f32_16x16x32_bf16 v[32:35], v[24:27], a[44:47], v[32:35]
    v_mfma_f32_16x16x32_bf16 v[36:39], v[28:31], a[44:47], v[36:39]
    v_mfma_f32_16x16x32_bf16 v[40:43], v[24:27], a[100:103], v[40:43]
    v_mfma_f32_16x16x32_bf16 v[44:47], v[28:31], a[100:103], v[44:47]
    v_mfma_f32_16x16x32_bf16 v[48:51], v[24:27], a[156:159], v[48:51]
    v_mfma_f32_16x16x32_bf16 v[52:55], v[28:31], a[156:159], v[52:55]
    v_mfma_f32_16x16x32_bf16 v[56:59], v[24:27], a[212:215], v[56:59]
    v_mfma_f32_16x16x32_bf16 v[60:63], v[28:31], a[212:215], v[60:63]
    v_mfma_f32_16x16x32_bf16 v[64:67], v[24:27], v[132:135], v[64:67]
    v_mfma_f32_16x16x32_bf16 v[68:71], v[28:31], v[132:135], v[68:71]
    v_mfma_f32_16x16x32_bf16 v[72:75], v[24:27], v[188:191], v[72:75]
    v_mfma_f32_16x16x32_bf16 v[76:79], v[28:31], v[188:191], v[76:79]
    v_mfma_f32_16x16x32_bf16 v[80:83], v[24:27], v[244:247], v[80:83]
    v_mfma_f32_16x16x32_bf16 v[84:87], v[28:31], v[244:247], v[84:87]
    ds_read_b128 v[24:27], v9 offset:26624
    ds_read_b128 v[28:31], v9 offset:27648
    s_waitcnt lgkmcnt(2)
    v_mfma_f32_16x16x32_bf16 v[32:35], v[16:19], a[48:51], v[32:35]
    v_mfma_f32_16x16x32_bf16 v[36:39], v[20:23], a[48:51], v[36:39]
    v_mfma_f32_16x16x32_bf16 v[40:43], v[16:19], a[104:107], v[40:43]
    v_mfma_f32_16x16x32_bf16 v[44:47], v[20:23], a[104:107], v[44:47]
    v_mfma_f32_16x16x32_bf16 v[48:51], v[16:19], a[160:163], v[48:51]
    v_mfma_f32_16x16x32_bf16 v[52:55], v[20:23], a[160:163], v[52:55]
    v_mfma_f32_16x16x32_bf16 v[56:59], v[16:19], a[216:219], v[56:59]
    v_mfma_f32_16x16x32_bf16 v[60:63], v[20:23], a[216:219], v[60:63]
    v_mfma_f32_16x16x32_bf16 v[64:67], v[16:19], v[136:139], v[64:67]
    v_mfma_f32_16x16x32_bf16 v[68:71], v[20:23], v[136:139], v[68:71]
    v_mfma_f32_16x16x32_bf16 v[72:75], v[16:19], v[192:195], v[72:75]
    v_mfma_f32_16x16x32_bf16 v[76:79], v[20:23], v[192:195], v[76:79]
    v_mfma_f32_16x16x32_bf16 v[80:83], v[16:19], v[248:251], v[80:83]
    v_mfma_f32_16x16x32_bf16 v[84:87], v[20:23], v[248:251], v[84:87]
    s_waitcnt lgkmcnt(0)
    v_mfma_f32_16x16x32_bf16 v[32:35], v[24:27], a[52:55], v[32:35]
    v_mfma_f32_16x16x32_bf16 v[36:39], v[28:31], a[52:55], v[36:39]
    v_mfma_f32_16x16x32_bf16 v[40:43], v[24:27], a[108:111], v[40:43]
    v_mfma_f32_16x16x32_bf16 v[44:47], v[28:31], a[108:111], v[44:47]
    v_mfma_f32_16x16x32_bf16 v[48:51], v[24:27], a[164:167], v[48:51]
    v_mfma_f32_16x16x32_bf16 v[52:55], v[28:31], a[164:167], v[52:55]
    v_mfma_f32_16x16x32_bf16 v[56:59], v[24:27], a[220:223], v[56:59]
    v_mfma_f32_16x16x32_bf16 v[60:63], v[28:31], a[220:223], v[60:63]
    v_mfma_f32_16x16x32_bf16 v[64:67], v[24:27], v[140:143], v[64:67]
    v_mfma_f32_16x16x32_bf16 v[68:71], v[28:31], v[140:143], v[68:71]
    v_mfma_f32_16x16x32_bf16 v[72:75], v[24:27], v[196:199], v[72:75]
    v_mfma_f32_16x16x32_bf16 v[76:79], v[28:31], v[196:199], v[76:79]
    v_mfma_f32_16x16x32_bf16 v[80:83], v[24:27], v[252:255], v[80:83]
    v_mfma_f32_16x16x32_bf16 v[84:87], v[28:31], v[252:255], v[84:87]
    s_lshl_b32 s33, s22, 4
    s_add_u32 s33, s33, s21
    s_mul_i32 s33, s33, 28672
    s_mul_i32 s34, s20, 1792
    s_add_u32 s33, s33, s34
    s_add_u32 s33, s33, 33554432
    s_add_u32 s34, s33, 14336
    s_nop 4
    v_cvt_pk_bf16_f32 v10, v32, v33
    v_cvt_pk_bf16_f32 v11, v34, v35
    buffer_store_dwordx2 v[10:11], v6, s[8:11], s33 offen offset:0 sc1
    v_cvt_pk_bf16_f32 v12, v36, v37
    v_cvt_pk_bf16_f32 v13, v38, v39
    buffer_store_dwordx2 v[12:13], v6, s[8:11], s34 offen offset:0 sc1
    v_cvt_pk_bf16_f32 v10, v40, v41
    v_cvt_pk_bf16_f32 v11, v42, v43
    buffer_store_dwordx2 v[10:11], v6, s[8:11], s33 offen offset:256 sc1
    v_cvt_pk_bf16_f32 v12, v44, v45
    v_cvt_pk_bf16_f32 v13, v46, v47
    buffer_store_dwordx2 v[12:13], v6, s[8:11], s34 offen offset:256 sc1
    v_cvt_pk_bf16_f32 v10, v48, v49
    v_cvt_pk_bf16_f32 v11, v50, v51
    buffer_store_dwordx2 v[10:11], v6, s[8:11], s33 offen offset:512 sc1
    v_cvt_pk_bf16_f32 v12, v52, v53
    v_cvt_pk_bf16_f32 v13, v54, v55
    buffer_store_dwordx2 v[12:13], v6, s[8:11], s34 offen offset:512 sc1
    v_cvt_pk_bf16_f32 v10, v56, v57
    v_cvt_pk_bf16_f32 v11, v58, v59
    buffer_store_dwordx2 v[10:11], v6, s[8:11], s33 offen offset:768 sc1
    v_cvt_pk_bf16_f32 v12, v60, v61
    v_cvt_pk_bf16_f32 v13, v62, v63
    buffer_store_dwordx2 v[12:13], v6, s[8:11], s34 offen offset:768 sc1
    v_cvt_pk_bf16_f32 v10, v64, v65
    v_cvt_pk_bf16_f32 v11, v66, v67
    buffer_store_dwordx2 v[10:11], v6, s[8:11], s33 offen offset:1024 sc1
    v_cvt_pk_bf16_f32 v12, v68, v69
    v_cvt_pk_bf16_f32 v13, v70, v71
    buffer_store_dwordx2 v[12:13], v6, s[8:11], s34 offen offset:1024 sc1
    v_cvt_pk_bf16_f32 v10, v72, v73
    v_cvt_pk_bf16_f32 v11, v74, v75
    buffer_store_dwordx2 v[10:11], v6, s[8:11], s33 offen offset:1280 sc1
    v_cvt_pk_bf16_f32 v12, v76, v77
    v_cvt_pk_bf16_f32 v13, v78, v79
    buffer_store_dwordx2 v[12:13], v6, s[8:11], s34 offen offset:1280 sc1
    v_cvt_pk_bf16_f32 v10, v80, v81
    v_cvt_pk_bf16_f32 v11, v82, v83
    buffer_store_dwordx2 v[10:11], v6, s[8:11], s33 offen offset:1536 sc1
    v_cvt_pk_bf16_f32 v12, v84, v85
    v_cvt_pk_bf16_f32 v13, v86, v87
    buffer_store_dwordx2 v[12:13], v6, s[8:11], s34 offen offset:1536 sc1
    s_waitcnt vmcnt(0)
    s_barrier
    s_cmp_eq_u32 s20, 0
    s_cbranch_scc0 W1_NOFLAG
    s_lshl_b32 s34, s22, 7
    s_add_u32 s34, s34, 32505856
    s_mov_b64 exec, 1
    buffer_atomic_add v7, v8, s[8:11], s34 offen
    s_mov_b64 exec, -1
W1_NOFLAG:
    s_sub_u32 s30, 28672, s30
    s_add_u32 s22, s22, s23
    s_cmp_lt_u32 s22, 64
    s_cbranch_scc1 W1_LOOP
    s_endpgm
ROLE_SCORE:
    v_lshlrev_b32 v4, 4, v0
    v_add_u32 v5, 4096, v4
    v_cmp_gt_u32 vcc, 192, v0
    s_nop 1
    v_cndmask_b32 v5, v4, v5, vcc
    v_and_b32 v7, 15, v2
    v_lshrrev_b32 v8, 4, v2
    v_mov_b32 v6, 0x4444
    v_mov_b32 v9, 0xeeee
    v_cmp_gt_u32 vcc, 8, v7
    s_nop 1
    v_cndmask_b32 v6, v9, v6, vcc
    v_and_b32 v9, 7, v7
    v_lshlrev_b32 v9, 4, v9
    v_lshl_add_u32 v9, v8, 7, v9
    s_mul_i32 s24, s21, 28
    s_mul_i32 s25, s20, 6
    s_add_u32 s24, s24, s25
    s_mul_i32 s24, s24, 14336
    s_add_u32 s24, s24, 9437184
    s_lshr_b32 s25, s20, 1
    s_add_u32 s25, s25, 12
    s_lshl_b32 s26, s25, 1
    s_and_b32 s27, s20, 1
    s_add_u32 s26, s26, s27
    s_mul_i32 s27, s21, 28
    s_add_u32 s26, s26, s27
    s_mul_i32 s26, s26, 14336
    s_add_u32 s26, s26, 9437184
    s_mul_i32 s41, s20, 7168
    s_add_u32 s33, s41, 0
    s_add_u32 s43, s41, 28672
    s_mov_b32 m0, s43
    s_nop 0
    buffer_load_dwordx4 v3, s[8:11], s33 offen offset:0  lds
    buffer_load_dwordx4 v3, s[8:11], s33 offen offset:1024  lds
    buffer_load_dwordx4 v3, s[8:11], s33 offen offset:2048  lds
    buffer_load_dwordx4 v3, s[8:11], s33 offen offset:3072  lds
    s_add_u32 s28, s43, 4096
    s_add_u32 s29, s33, 4096
    s_mov_b32 m0, s28
    s_nop 0
    buffer_load_dwordx4 v3, s[8:11], s29 offen offset:0  lds
    buffer_load_dwordx4 v3, s[8:11], s29 offen offset:1024  lds
    buffer_load_dwordx4 v3, s[8:11], s29 offen offset:2048  lds
    s_add_u32 s28, s24, 0
    buffer_load_dwordx4 a[0:3], v3, s[8:11], s28 offen offset:0
    buffer_load_dwordx4 a[4:7], v3, s[8:11], s28 offen offset:1024
    buffer_load_dwordx4 a[8:11], v3, s[8:11], s28 offen offset:2048
    buffer_load_dwordx4 a[12:15], v3, s[8:11], s28 offen offset:3072
    s_add_u32 s28, s24, 4096
    buffer_load_dwordx4 a[16:19], v3, s[8:11], s28 offen offset:0
    buffer_load_dwordx4 a[20:23], v3, s[8:11], s28 offen offset:1024
    buffer_load_dwordx4 a[24:27], v3, s[8:11], s28 offen offset:2048
    buffer_load_dwordx4 a[28:31], v3, s[8:11], s28 offen offset:3072
    s_add_u32 s28, s24, 8192
    buffer_load_dwordx4 a[32:35], v3, s[8:11], s28 offen offset:0
    buffer_load_dwordx4 a[36:39], v3, s[8:11], s28 offen offset:1024
    buffer_load_dwordx4 a[40:43], v3, s[8:11], s28 offen offset:2048
    buffer_load_dwordx4 a[44:47], v3, s[8:11], s28 offen offset:3072
    s_add_u32 s28, s24, 12288
    buffer_load_dwordx4 a[48:51], v3, s[8:11], s28 offen offset:0
    buffer_load_dwordx4 a[52:55], v3, s[8:11], s28 offen offset:1024
    buffer_load_dwordx4 a[56:59], v3, s[8:11], s28 offen offset:2048
    buffer_load_dwordx4 a[60:63], v3, s[8:11], s28 offen offset:3072
    s_add_u32 s28, s24, 16384
    buffer_load_dwordx4 a[64:67], v3, s[8:11], s28 offen offset:0
    buffer_load_dwordx4 a[68:71], v3, s[8:11], s28 offen offset:1024
    buffer_load_dwordx4 a[72:75], v3, s[8:11], s28 offen offset:2048
    buffer_load_dwordx4 a[76:79], v3, s[8:11], s28 offen offset:3072
    s_add_u32 s28, s24, 20480
    buffer_load_dwordx4 a[80:83], v3, s[8:11], s28 offen offset:0
    buffer_load_dwordx4 a[84:87], v3, s[8:11], s28 offen offset:1024
    buffer_load_dwordx4 a[88:91], v3, s[8:11], s28 offen offset:2048
    buffer_load_dwordx4 a[92:95], v3, s[8:11], s28 offen offset:3072
    s_add_u32 s28, s24, 24576
    buffer_load_dwordx4 a[96:99], v3, s[8:11], s28 offen offset:0
    buffer_load_dwordx4 a[100:103], v3, s[8:11], s28 offen offset:1024
    buffer_load_dwordx4 a[104:107], v3, s[8:11], s28 offen offset:2048
    buffer_load_dwordx4 a[108:111], v3, s[8:11], s28 offen offset:3072
    s_add_u32 s28, s24, 28672
    buffer_load_dwordx4 a[112:115], v3, s[8:11], s28 offen offset:0
    buffer_load_dwordx4 a[116:119], v3, s[8:11], s28 offen offset:1024
    buffer_load_dwordx4 a[120:123], v3, s[8:11], s28 offen offset:2048
    buffer_load_dwordx4 a[124:127], v3, s[8:11], s28 offen offset:3072
    s_add_u32 s28, s24, 32768
    buffer_load_dwordx4 a[128:131], v3, s[8:11], s28 offen offset:0
    buffer_load_dwordx4 a[132:135], v3, s[8:11], s28 offen offset:1024
    buffer_load_dwordx4 a[136:139], v3, s[8:11], s28 offen offset:2048
    buffer_load_dwordx4 a[140:143], v3, s[8:11], s28 offen offset:3072
    s_add_u32 s28, s24, 36864
    buffer_load_dwordx4 a[144:147], v3, s[8:11], s28 offen offset:0
    buffer_load_dwordx4 a[148:151], v3, s[8:11], s28 offen offset:1024
    buffer_load_dwordx4 a[152:155], v3, s[8:11], s28 offen offset:2048
    buffer_load_dwordx4 a[156:159], v3, s[8:11], s28 offen offset:3072
    s_add_u32 s28, s24, 40960
    buffer_load_dwordx4 a[160:163], v3, s[8:11], s28 offen offset:0
    buffer_load_dwordx4 a[164:167], v3, s[8:11], s28 offen offset:1024
    buffer_load_dwordx4 a[168:171], v3, s[8:11], s28 offen offset:2048
    buffer_load_dwordx4 a[172:175], v3, s[8:11], s28 offen offset:3072
    s_add_u32 s28, s24, 45056
    buffer_load_dwordx4 a[176:179], v3, s[8:11], s28 offen offset:0
    buffer_load_dwordx4 a[180:183], v3, s[8:11], s28 offen offset:1024
    buffer_load_dwordx4 a[184:187], v3, s[8:11], s28 offen offset:2048
    buffer_load_dwordx4 a[188:191], v3, s[8:11], s28 offen offset:3072
    s_add_u32 s28, s24, 49152
    buffer_load_dwordx4 a[192:195], v3, s[8:11], s28 offen offset:0
    buffer_load_dwordx4 a[196:199], v3, s[8:11], s28 offen offset:1024
    buffer_load_dwordx4 a[200:203], v3, s[8:11], s28 offen offset:2048
    buffer_load_dwordx4 a[204:207], v3, s[8:11], s28 offen offset:3072
    s_add_u32 s28, s24, 53248
    buffer_load_dwordx4 a[208:211], v3, s[8:11], s28 offen offset:0
    buffer_load_dwordx4 a[212:215], v3, s[8:11], s28 offen offset:1024
    buffer_load_dwordx4 a[216:219], v3, s[8:11], s28 offen offset:2048
    buffer_load_dwordx4 a[220:223], v3, s[8:11], s28 offen offset:3072
    s_add_u32 s28, s24, 57344
    buffer_load_dwordx4 a[224:227], v3, s[8:11], s28 offen offset:0
    buffer_load_dwordx4 a[228:231], v3, s[8:11], s28 offen offset:1024
    buffer_load_dwordx4 a[232:235], v3, s[8:11], s28 offen offset:2048
    buffer_load_dwordx4 a[236:239], v3, s[8:11], s28 offen offset:3072
    s_add_u32 s28, s24, 61440
    buffer_load_dwordx4 a[240:243], v3, s[8:11], s28 offen offset:0
    buffer_load_dwordx4 a[244:247], v3, s[8:11], s28 offen offset:1024
    buffer_load_dwordx4 a[248:251], v3, s[8:11], s28 offen offset:2048
    buffer_load_dwordx4 a[252:255], v3, s[8:11], s28 offen offset:3072
    s_add_u32 s28, s24, 65536
    buffer_load_dwordx4 v[120:123], v3, s[8:11], s28 offen offset:0
    buffer_load_dwordx4 v[124:127], v3, s[8:11], s28 offen offset:1024
    buffer_load_dwordx4 v[128:131], v3, s[8:11], s28 offen offset:2048
    buffer_load_dwordx4 v[132:135], v3, s[8:11], s28 offen offset:3072
    s_add_u32 s28, s24, 69632
    buffer_load_dwordx4 v[136:139], v3, s[8:11], s28 offen offset:0
    buffer_load_dwordx4 v[140:143], v3, s[8:11], s28 offen offset:1024
    buffer_load_dwordx4 v[144:147], v3, s[8:11], s28 offen offset:2048
    buffer_load_dwordx4 v[148:151], v3, s[8:11], s28 offen offset:3072
    s_add_u32 s28, s24, 73728
    buffer_load_dwordx4 v[152:155], v3, s[8:11], s28 offen offset:0
    buffer_load_dwordx4 v[156:159], v3, s[8:11], s28 offen offset:1024
    buffer_load_dwordx4 v[160:163], v3, s[8:11], s28 offen offset:2048
    buffer_load_dwordx4 v[164:167], v3, s[8:11], s28 offen offset:3072
    s_add_u32 s28, s24, 77824
    buffer_load_dwordx4 v[168:171], v3, s[8:11], s28 offen offset:0
    buffer_load_dwordx4 v[172:175], v3, s[8:11], s28 offen offset:1024
    buffer_load_dwordx4 v[176:179], v3, s[8:11], s28 offen offset:2048
    buffer_load_dwordx4 v[180:183], v3, s[8:11], s28 offen offset:3072
    s_add_u32 s28, s24, 81920
    buffer_load_dwordx4 v[184:187], v3, s[8:11], s28 offen offset:0
    buffer_load_dwordx4 v[188:191], v3, s[8:11], s28 offen offset:1024
    buffer_load_dwordx4 v[192:195], v3, s[8:11], s28 offen offset:2048
    buffer_load_dwordx4 v[196:199], v3, s[8:11], s28 offen offset:3072
    s_add_u32 s28, s26, 0
    buffer_load_dwordx4 v[200:203], v3, s[8:11], s28 offen offset:0
    buffer_load_dwordx4 v[204:207], v3, s[8:11], s28 offen offset:1024
    buffer_load_dwordx4 v[208:211], v3, s[8:11], s28 offen offset:2048
    buffer_load_dwordx4 v[212:215], v3, s[8:11], s28 offen offset:3072
    s_add_u32 s28, s26, 4096
    buffer_load_dwordx4 v[216:219], v3, s[8:11], s28 offen offset:0
    buffer_load_dwordx4 v[220:223], v3, s[8:11], s28 offen offset:1024
    buffer_load_dwordx4 v[224:227], v3, s[8:11], s28 offen offset:2048
    buffer_load_dwordx4 v[228:231], v3, s[8:11], s28 offen offset:3072
    s_add_u32 s28, s26, 8192
    buffer_load_dwordx4 v[232:235], v3, s[8:11], s28 offen offset:0
    buffer_load_dwordx4 v[236:239], v3, s[8:11], s28 offen offset:1024
    buffer_load_dwordx4 v[240:243], v3, s[8:11], s28 offen offset:2048
    buffer_load_dwordx4 v[244:247], v3, s[8:11], s28 offen offset:3072
    s_add_u32 s28, s26, 12288
    buffer_load_dwordx4 v[248:251], v3, s[8:11], s28 offen offset:0
    buffer_load_dwordx4 v[252:255], v3, s[8:11], s28 offen offset:1024
    v_lshrrev_b32 v10, 3, v7
    v_mul_u32_u24 v10, 28, v10
    v_add_u32 v10, v10, v8
    v_lshlrev_b32 v10, 7, v10
    v_and_b32 v11, 7, v7
    v_lshl_add_u32 v65, v11, 4, v10
    v_and_b32 v11, 1, v7
    v_lshlrev_b32 v11, 4, v11
    v_mov_b32 v12, 0x3f80
    v_lshlrev_b32 v11, v11, v12
    v_lshrrev_b32 v10, 2, v7
    v_and_b32 v13, 1, v8
    v_and_b32 v14, 2, v7
    v_cmp_eq_u32 vcc, v10, v13
    s_nop 1
    v_cndmask_b32 v15, 0, v11, vcc
    v_add_u32 v13, 2, v13
    v_cmp_eq_u32 vcc, v10, v13
    s_nop 1
    v_cndmask_b32 v16, 0, v11, vcc
    v_cmp_eq_u32 vcc, 0, v14
    s_nop 1
    v_cndmask_b32 v108, 0, v15, vcc
    v_cndmask_b32 v109, v15, 0, vcc
    v_cndmask_b32 v110, 0, v16, vcc
    v_cndmask_b32 v111, v16, 0, vcc
    s_and_b32 s44, s20, 1
    s_cmp_eq_u32 s44, 0
    s_cselect_b64 vcc, -1, 0
    v_cndmask_b32 v112, v110, v108, vcc
    v_cndmask_b32 v113, v111, v109, vcc
    v_mov_b32 v114, 0
    v_mov_b32 v115, 0
    s_mul_i32 s28, s20, 3
    v_and_b32 v10, 1, v8
    v_lshrrev_b32 v11, 1, v8
    v_add_u32 v12, s28, v10
    s_add_u32 s29, s28, 2
    v_mov_b32 v13, s29
    v_mov_b32 v14, s25
    v_cmp_eq_u32 vcc, 0, v10
    s_nop 1
    v_cndmask_b32 v13, v14, v13, vcc
    v_lshl_add_u32 v14, v11, 4, v7
    v_lshlrev_b32 v14, 4, v14
    v_lshl_add_u32 v116, v12, 11, v14
    v_add_u32 v116, 28672, v116
    v_lshl_add_u32 v14, v12, 2, v11
    v_lshlrev_b32 v14, 7, v14
    v_and_b32 v15, 7, v7
    v_lshl_add_u32 v118, v15, 4, v14
    v_lshl_add_u32 v14, v11, 4, v7
    v_lshlrev_b32 v14, 4, v14
    v_lshl_add_u32 v117, v13, 11, v14
    v_add_u32 v117, 28672, v117
    v_lshl_add_u32 v14, v13, 2, v11
    v_lshlrev_b32 v14, 7, v14
    v_and_b32 v15, 7, v7
    v_lshl_add_u32 v119, v15, 4, v14
    s_lshl_b32 s28, s20, 1
    v_add_u32 v14, s28, v11
    v_mul_u32_u24 v14, 48, v14
    v_add_u32 v14, v14, v7
    v_mul_u32_u24 v14, 48, v14
    v_lshl_add_u32 v14, v10, 4, v14
    v_add_u32 v9, 8192, v14
    v_min_u32 v14, 47, v2
    v_mul_u32_u24 v14, 48, v14
    s_lshl_b32 s28, s20, 3
    s_add_u32 s28, s28, 8192
    v_add_u32 v66, s28, v14
    v_bfe_u32 v10, v2, 1, 1
    v_lshlrev_b32 v10, 3, v10
    v_bfe_u32 v11, v2, 4, 1
    v_lshl_add_u32 v10, v11, 4, v10
    v_lshlrev_b32 v10, 4, v10
    v_bfe_u32 v11, v2, 2, 2
    v_lshl_add_u32 v10, v11, 2, v10
    s_and_b32 s28, s21, 1
    s_lshl_b32 s28, s28, 9
    s_bfe_u32 s29, s21, 0x10001
    s_lshl_b32 s29, s29, 10
    s_add_u32 s28, s28, s29
    v_add_u32 v10, s28, v10
    v_bfe_u32 v11, v2, 2, 1
    v_lshlrev_b32 v11, 8, v11
    v_bfe_u32 v12, v2, 1, 1
    v_lshl_add_u32 v11, v12, 2, v11
    s_and_b32 s28, s21, 1
    s_lshl_b32 s28, s28, 9
    s_bfe_u32 s29, s21, 0x10001
    s_lshl_b32 s29, s29, 3
    s_add_u32 s28, s28, s29
    s_add_u32 s28, s28, 2048
    v_add_u32 v11, s28, v11
    v_cmp_gt_u32 vcc, 32, v2
    s_nop 1
    v_cndmask_b32 v10, v11, v10, vcc
    s_lshr_b32 s28, s21, 2
    s_mul_i32 s28, s28, 3072
    s_lshl_b32 s29, s20, 5
    s_add_u32 s28, s28, s29
    v_add_u32 v67, s28, v10
    v_mov_b32 v1, v66
    v_mov_b32 v2, v67
    s_mov_b32 s36, -1
    s_mov_b32 s37, 0xff
    s_mov_b32 s38, 0x55555555
    s_mov_b32 s39, 0x55
    v_mov_b32 v7, 0
    v_mov_b32 v8, 0
    v_mov_b32 v0, v65
    v_mov_b32 v92, 0
    v_mov_b32 v93, 0
    v_mov_b32 v94, 0
    v_mov_b32 v95, 0
    s_add_u32 s12, s4, 32555008
    s_addc_u32 s13, s5, 0
    s_mov_b32 s14, 4096
    s_mov_b32 s15, 0x00020000
    s_mov_b32 s30, 0
    s_mov_b32 s31, 30408704
    s_mov_b32 s32, 31457280
    v_mov_b32 v40, 0
    v_mov_b32 v41, 0
    v_mov_b32 v42, 0
    v_mov_b32 v43, 0
    v_mov_b32 v44, 0
    v_mov_b32 v45, 0
    v_mov_b32 v46, 0
    v_mov_b32 v47, 0
    v_mov_b32 v48, 0
    v_mov_b32 v49, 0
    v_mov_b32 v50, 0
    v_mov_b32 v51, 0
    v_mov_b32 v52, 0
    v_mov_b32 v53, 0
    v_mov_b32 v54, 0
    v_mov_b32 v55, 0
    v_mov_b32 v56, 0
    v_mov_b32 v57, 0
    v_mov_b32 v58, 0
    v_mov_b32 v59, 0
    v_mov_b32 v60, 0
    v_mov_b32 v61, 0
    v_mov_b32 v62, 0
    v_mov_b32 v63, 0
    v_mov_b32 v64, 0
    v_mov_b32 v65, 0
    v_mov_b32 v66, 0
    v_mov_b32 v67, 0
    v_mov_b32 v96, 0
    v_mov_b32 v97, 0
    v_mov_b32 v98, 0
    v_mov_b32 v99, 0
    v_mov_b32 v100, 0
    v_mov_b32 v101, 0
    v_mov_b32 v102, 0
    v_mov_b32 v103, 0
    v_mov_b32 v104, 0
    v_mov_b32 v105, 0
    v_mov_b32 v106, 0
    v_mov_b32 v107, 0
    s_cmp_eq_u32 s48, 2
    s_cbranch_scc0 DME_7
    s_mov_b32 s34, 0
DM_6:
    s_mov_b32 s42, 32546816
    buffer_load_dword v10, v114, s[8:11], s42 offen sc1
    s_mov_b32 s42, 32547840
    buffer_load_dword v11, v114, s[8:11], s42 offen sc1
    s_add_u32 s34, s34, 1
    s_cmp_gt_u32 s34, 4194304
    s_cbranch_scc1 CH_ABORT
    s_waitcnt vmcnt(0)
    v_readfirstlane_b32 s45, v10
    v_readfirstlane_b32 s46, v11
    s_nop 3
    s_mov_b32 s48, 0
    s_cmp_ge_u32 s45, 30
    s_cbranch_scc1 DME_7
    s_cmp_lt_u32 s46, 256
    s_cbranch_scc1 DM_6
    s_mov_b32 s42, 32546816
    buffer_load_dword v10, v114, s[8:11], s42 offen sc1
    s_waitcnt vmcnt(0)
    v_readfirstlane_b32 s45, v10
    s_nop 3
    s_cmp_ge_u32 s45, 30
    s_cselect_b32 s48, 0, 1
DME_7:
    s_waitcnt vmcnt(0)
    s_and_b32 s44, s20, 1
SC_LOOP:
    s_cmp_eq_u32 s30, 0
    s_cbranch_scc1 SC_NOH
SC_NOH:
    s_mov_b32 s34, 0
PLS_8:
    buffer_load_dwordx4 v[68:71], v4, s[8:11], s31 offen sc1
    buffer_load_dwordx4 v[72:75], v5, s[8:11], s31 offen sc1
    s_waitcnt vmcnt(0)
    v_max3_u32 v10, v68, v69, v70
    v_max3_u32 v11, v71, v72, v73
    v_max3_u32 v10, v10, v74, v75
    v_max_u32 v10, v10, v11
    v_cmp_eq_u32 vcc, -1, v10
    s_cbranch_vccz PDS_10
    s_add_u32 s34, s34, 1
    s_cmp_lt_u32 s34, 4194304
    s_cbranch_scc1 PLS_8
    s_branch CH_ABORT
PDS_10:
    ds_write_b128 v4, v[68:71]
    ds_write_b128 v5, v[72:75]
PES_9:
    s_waitcnt lgkmcnt(0)
    s_barrier
    ds_read_b128 v[12:15], v0 offset:0
    ds_read_b128 v[16:19], v0 offset:512
    ds_read_b128 v[20:23], v0 offset:1024
    ds_read_b128 v[24:27], v0 offset:1536
    ds_read_b128 v[28:31], v0 offset:2048
    ds_read_b128 v[32:35], v0 offset:2560
    ds_read_b128 v[36:39], v0 offset:3072
    s_waitcnt lgkmcnt(6)
    v_smfmac_f32_16x16x64_bf16 v[64:67], v[12:15], v[200:207], v6
    s_waitcnt lgkmcnt(5)
    v_smfmac_f32_16x16x64_bf16 v[64:67], v[16:19], v[208:215], v6
    s_waitcnt lgkmcnt(4)
    v_smfmac_f32_16x16x64_bf16 v[64:67], v[20:23], v[216:223], v6
    s_waitcnt lgkmcnt(3)
    v_smfmac_f32_16x16x64_bf16 v[64:67], v[24:27], v[224:231], v6
    s_waitcnt lgkmcnt(2)
    v_smfmac_f32_16x16x64_bf16 v[64:67], v[28:31], v[232:239], v6
    s_waitcnt lgkmcnt(1)
    v_smfmac_f32_16x16x64_bf16 v[64:67], v[32:35], v[240:247], v6
    s_waitcnt lgkmcnt(0)
    v_smfmac_f32_16x16x64_bf16 v[64:67], v[36:39], v[248:255], v6
    v_smfmac_f32_16x16x64_bf16 v[56:59], v[12:15], a[224:231], v6
    v_smfmac_f32_16x16x64_bf16 v[56:59], v[16:19], a[232:239], v6
    v_smfmac_f32_16x16x64_bf16 v[56:59], v[20:23], a[240:247], v6
    s_waitcnt vmcnt(0)
    v_smfmac_f32_16x16x64_bf16 v[56:59], v[24:27], a[248:255], v6
    v_cvt_pk_bf16_f32 v92, v64, v65
    v_cvt_pk_bf16_f32 v93, v66, v67
    v_smfmac_f32_16x16x64_bf16 v[56:59], v[28:31], v[120:127], v6
    ds_read_b128 v[68:71], v117 offset:0
    ds_read_b128 v[72:75], v117 offset:512
    v_smfmac_f32_16x16x64_bf16 v[56:59], v[32:35], v[128:135], v6
    ds_read_b128 v[76:79], v117 offset:1024
    ds_read_b128 v[80:83], v117 offset:1536
    v_mfma_f32_16x16x32_bf16 v[64:67], v[92:95], v[112:115], 0
    v_smfmac_f32_16x16x64_bf16 v[56:59], v[36:39], v[136:143], v6
    ds_read_b128 v[84:87], v119
    ds_read_b128 v[88:91], v119 offset:256
    v_smfmac_f32_16x16x64_bf16 v[60:63], v[12:15], v[144:151], v6
    v_smfmac_f32_16x16x64_bf16 v[60:63], v[16:19], v[152:159], v6
    v_smfmac_f32_16x16x64_bf16 v[60:63], v[20:23], v[160:167], v6
    v_smfmac_f32_16x16x64_bf16 v[60:63], v[24:27], v[168:175], v6
    v_cvt_pk_bf16_f32 v92, v56, v57
    v_cvt_pk_bf16_f32 v93, v58, v59
    v_smfmac_f32_16x16x64_bf16 v[60:63], v[28:31], v[176:183], v6
    v_smfmac_f32_16x16x64_bf16 v[60:63], v[32:35], v[184:191], v6
    v_smfmac_f32_16x16x64_bf16 v[60:63], v[36:39], v[192:199], v6
    v_smfmac_f32_16x16x64_bf16 v[40:43], v[12:15], a[0:7], v6
    v_smfmac_f32_16x16x64_bf16 v[40:43], v[16:19], a[8:15], v6
    v_smfmac_f32_16x16x64_bf16 v[40:43], v[20:23], a[16:23], v6
    v_smfmac_f32_16x16x64_bf16 v[40:43], v[24:27], a[24:31], v6
    v_cvt_pk_bf16_f32 v94, v60, v61
    v_cvt_pk_bf16_f32 v95, v62, v63
    v_smfmac_f32_16x16x64_bf16 v[40:43], v[28:31], a[32:39], v6
    v_smfmac_f32_16x16x64_bf16 v[40:43], v[32:35], a[40:47], v6
    v_mfma_f32_16x16x32_bf16 v[56:59], v[92:95], v[108:111], 0
    v_smfmac_f32_16x16x64_bf16 v[40:43], v[36:39], a[48:55], v6
    v_smfmac_f32_16x16x64_bf16 v[44:47], v[12:15], a[56:63], v6
    v_smfmac_f32_16x16x64_bf16 v[44:47], v[16:19], a[64:71], v6
    v_smfmac_f32_16x16x64_bf16 v[44:47], v[20:23], a[72:79], v6
    v_cvt_pk_bf16_f32 v60, v56, v57
    v_cvt_pk_bf16_f32 v61, v58, v59
    v_smfmac_f32_16x16x64_bf16 v[44:47], v[24:27], a[80:87], v6
    v_cvt_pk_bf16_f32 v62, v64, v65
    v_cvt_pk_bf16_f32 v63, v66, v67
    v_smfmac_f32_16x16x64_bf16 v[44:47], v[28:31], a[88:95], v6
    v_smfmac_f32_16x16x64_bf16 v[44:47], v[32:35], a[96:103], v6
    s_waitcnt lgkmcnt(0)
    v_smfmac_f32_16x16x64_bf16 v[96:99], v[60:63], v[68:75], v6
    v_smfmac_f32_16x16x64_bf16 v[100:103], v[60:63], v[76:83], v6
    v_smfmac_f32_16x16x64_bf16 v[104:107], v[60:63], v[84:91], v6
    v_smfmac_f32_16x16x64_bf16 v[44:47], v[36:39], a[104:111], v6
    v_cvt_pk_bf16_f32 v92, v40, v41
    v_cvt_pk_bf16_f32 v93, v42, v43
    v_smfmac_f32_16x16x64_bf16 v[48:51], v[12:15], a[112:119], v6
    ds_read_b128 v[68:71], v116 offset:0
    ds_read_b128 v[72:75], v116 offset:512
    v_smfmac_f32_16x16x64_bf16 v[48:51], v[16:19], a[120:127], v6
    ds_read_b128 v[76:79], v116 offset:1024
    ds_read_b128 v[80:83], v116 offset:1536
    v_smfmac_f32_16x16x64_bf16 v[48:51], v[20:23], a[128:135], v6
    ds_read_b128 v[84:87], v118
    ds_read_b128 v[88:91], v118 offset:256
    v_smfmac_f32_16x16x64_bf16 v[48:51], v[24:27], a[136:143], v6
    v_cvt_pk_bf16_f32 v94, v44, v45
    v_cvt_pk_bf16_f32 v95, v46, v47
    v_smfmac_f32_16x16x64_bf16 v[48:51], v[28:31], a[144:151], v6
    v_smfmac_f32_16x16x64_bf16 v[48:51], v[32:35], a[152:159], v6
    v_mfma_f32_16x16x32_bf16 v[40:43], v[92:95], v[108:111], 0
    v_smfmac_f32_16x16x64_bf16 v[48:51], v[36:39], a[160:167], v6
    v_smfmac_f32_16x16x64_bf16 v[52:55], v[12:15], a[168:175], v6
    v_smfmac_f32_16x16x64_bf16 v[52:55], v[16:19], a[176:183], v6
    v_smfmac_f32_16x16x64_bf16 v[52:55], v[20:23], a[184:191], v6
    v_cvt_pk_bf16_f32 v44, v40, v41
    v_cvt_pk_bf16_f32 v45, v42, v43
    v_smfmac_f32_16x16x64_bf16 v[52:55], v[24:27], a[192:199], v6
    v_cvt_pk_bf16_f32 v92, v48, v49
    v_cvt_pk_bf16_f32 v93, v50, v51
    v_smfmac_f32_16x16x64_bf16 v[52:55], v[28:31], a[200:207], v6
    v_smfmac_f32_16x16x64_bf16 v[52:55], v[32:35], a[208:215], v6
    v_smfmac_f32_16x16x64_bf16 v[52:55], v[36:39], a[216:223], v6
    s_add_u32 s33, s33, 28672
    s_add_u32 s31, s31, 7168
    s_nop 5
    v_cvt_pk_bf16_f32 v94, v52, v53
    v_cvt_pk_bf16_f32 v95, v54, v55
    s_nop 1
    v_mfma_f32_16x16x32_bf16 v[48:51], v[92:95], v[108:111], 0
    s_nop 7
    v_cvt_pk_bf16_f32 v46, v48, v49
    v_cvt_pk_bf16_f32 v47, v50, v51
    s_waitcnt lgkmcnt(0)
    s_nop 0
    v_smfmac_f32_16x16x64_bf16 v[96:99], v[44:47], v[68:75], v6
    v_smfmac_f32_16x16x64_bf16 v[100:103], v[44:47], v[76:83], v6
    v_smfmac_f32_16x16x64_bf16 v[104:107], v[44:47], v[84:91], v6
    s_nop 5
    ds_write_b128 v9, v[96:99] offset:0
    ds_write_b128 v9, v[100:103] offset:768
    ds_write_b128 v9, v[104:107] offset:1536
    s_waitcnt lgkmcnt(0)
    s_barrier
    ds_read_b64 v[12:13], v1 offset:0
    ds_read_b64 v[14:15], v1 offset:2304
    ds_read_b64 v[16:17], v1 offset:4608
    ds_read_b64 v[18:19], v1 offset:6912
    ds_read_b64 v[20:21], v1 offset:9216
    ds_read_b64 v[22:23], v1 offset:11520
    ds_read_b64 v[24:25], v1 offset:13824
    ds_read_b64 v[26:27], v1 offset:16128
    s_waitcnt lgkmcnt(4)
    v_pk_add_f32 v[12:13], v[12:13], v[14:15]
    v_pk_add_f32 v[16:17], v[16:17], v[18:19]
    s_waitcnt lgkmcnt(0)
    v_pk_add_f32 v[20:21], v[20:21], v[22:23]
    v_pk_add_f32 v[24:25], v[24:25], v[26:27]
    v_pk_add_f32 v[12:13], v[12:13], v[16:17]
    v_pk_add_f32 v[20:21], v[20:21], v[24:25]
    v_pk_add_f32 v[12:13], v[12:13], v[20:21]
    s_mov_b64 exec, s[36:37]
    v_max_f32 v14, |v12|, |v13|
    v_cmp_lt_f32 vcc, 0x42700000, v14
    s_cbranch_vccnz SC_SLOW
SC_EXP:
    v_exp_f32 v7, v12
    v_exp_f32 v8, v13
    s_mov_b64 exec, -1
    v_add_f32_dpp v14, v7, v7 quad_perm:[1,0,3,2] row_mask:0xf bank_mask:0xf
    v_add_f32_dpp v15, v8, v8 quad_perm:[1,0,3,2] row_mask:0xf bank_mask:0xf
    s_nop 0
    v_add_f32_dpp v14, v14, v14 quad_perm:[2,3,0,1] row_mask:0xf bank_mask:0xf
    v_add_f32_dpp v15, v15, v15 quad_perm:[2,3,0,1] row_mask:0xf bank_mask:0xf
    s_nop 0
    v_add_f32_dpp v14, v14, v14 row_half_mirror row_mask:0xf bank_mask:0xf
    v_add_f32_dpp v15, v15, v15 row_half_mirror row_mask:0xf bank_mask:0xf
    s_nop 0
    v_add_f32_dpp v14, v14, v14 row_mirror row_mask:0xf bank_mask:0xf
    v_add_f32_dpp v15, v15, v15 row_mirror row_mask:0xf bank_mask:0xf
    s_nop 0
    v_add_f32_dpp v14, v14, v14 row_bcast:15 row_mask:0xa bank_mask:0xf
    v_add_f32_dpp v15, v15, v15 row_bcast:15 row_mask:0xa bank_mask:0xf
    s_nop 0
    v_add_f32_dpp v14, v14, v14 row_bcast:31 row_mask:0xc bank_mask:0xf
    v_add_f32_dpp v15, v15, v15 row_bcast:31 row_mask:0xc bank_mask:0xf
    s_nop 0
    v_readlane_b32 s46, v14, 63
    v_readlane_b32 s47, v15, 63
    s_nop 0
    v_rcp_f32 v14, s46
    v_rcp_f32 v15, s47
    s_nop 0
    v_mul_f32 v12, v7, v14
    v_mul_f32 v13, v8, v15
    s_nop 0
    v_mov_b32_dpp v14, v12 quad_perm:[1,0,3,2] row_mask:0xf bank_mask:0xf
    v_mov_b32_dpp v15, v13 quad_perm:[1,0,3,2] row_mask:0xf bank_mask:0xf
    s_mov_b64 exec, s[38:39]
    v_cvt_pk_bf16_f32 v12, v12, v14
    v_cvt_pk_bf16_f32 v13, v13, v15
    v_min_u32 v12, 0xfffffffe, v12
    v_min_u32 v13, 0xfffffffe, v13
    s_cmp_eq_u32 s48, 0
    s_cbranch_scc0 SM_11
    buffer_store_dword v12, v2, s[8:11], s32 offen
    buffer_store_dword v13, v2, s[8:11], s32 offen offset:16
    s_branch SME_12
SM_11:
    buffer_store_dword v12, v2, s[8:11], s32 offen sc1
    buffer_store_dword v13, v2, s[8:11], s32 offen offset:16 sc1
SME_12:
    s_mov_b64 exec, -1
    s_or_b32 s49, s21, s20
    s_cmp_eq_u32 s49, 0
    s_cbranch_scc0 PH_13
    s_add_u32 s49, s30, 1
    v_mov_b32 v10, s49
    s_cmp_eq_u32 s48, 0
    s_cbranch_scc0 SM_14
    buffer_store_dword v10, v114, s[12:15], 0 offen offset:128
    s_branch SME_15
SM_14:
    buffer_store_dword v10, v114, s[12:15], 0 offen offset:128 sc1
SME_15:
PH_13:
    s_mov_b32 m0, s43
    s_nop 0
    buffer_load_dwordx4 v3, s[8:11], s33 offen offset:0  lds
    buffer_load_dwordx4 v3, s[8:11], s33 offen offset:1024  lds
    buffer_load_dwordx4 v3, s[8:11], s33 offen offset:2048  lds
    buffer_load_dwordx4 v3, s[8:11], s33 offen offset:3072  lds
    s_add_u32 s28, s43, 4096
    s_add_u32 s29, s33, 4096
    s_mov_b32 m0, s28
    s_nop 0
    buffer_load_dwordx4 v3, s[8:11], s29 offen offset:0  lds
    buffer_load_dwordx4 v3, s[8:11], s29 offen offset:1024  lds
    buffer_load_dwordx4 v3, s[8:11], s29 offen offset:2048  lds
    v_mov_b32 v40, 0
    v_mov_b32 v41, 0
    v_mov_b32 v42, 0
    v_mov_b32 v43, 0
    v_mov_b32 v44, 0
    v_mov_b32 v45, 0
    v_mov_b32 v46, 0
    v_mov_b32 v47, 0
    v_mov_b32 v48, 0
    v_mov_b32 v49, 0
    v_mov_b32 v50, 0
    v_mov_b32 v51, 0
    v_mov_b32 v52, 0
    v_mov_b32 v53, 0
    v_mov_b32 v54, 0
    v_mov_b32 v55, 0
    v_mov_b32 v56, 0
    v_mov_b32 v57, 0
    v_mov_b32 v58, 0
    v_mov_b32 v59, 0
    v_mov_b32 v60, 0
    v_mov_b32 v61, 0
    v_mov_b32 v62, 0
    v_mov_b32 v63, 0
    v_mov_b32 v64, 0
    v_mov_b32 v65, 0
    v_mov_b32 v66, 0
    v_mov_b32 v67, 0
    v_mov_b32 v96, 0
    v_mov_b32 v97, 0
    v_mov_b32 v98, 0
    v_mov_b32 v99, 0
    v_mov_b32 v100, 0
    v_mov_b32 v101, 0
    v_mov_b32 v102, 0
    v_mov_b32 v103, 0
    v_mov_b32 v104, 0
    v_mov_b32 v105, 0
    v_mov_b32 v106, 0
    v_mov_b32 v107, 0
    s_add_u32 s30, s30, 1
    s_add_u32 s32, s32, 12288
    s_cmp_lt_u32 s30, 63
    s_cbranch_scc1 SC_LOOP
    s_endpgm
SC_SLOW:
    s_mov_b64 exec, -1
    v_mov_b32 v16, 0xff800000
    s_nop 0
    v_cndmask_b32 v14, v16, v12, s[36:37]
    v_cndmask_b32 v15, v16, v13, s[36:37]
    s_nop 1
    v_max_f32_dpp v14, v14, v14 quad_perm:[1,0,3,2] row_mask:0xf bank_mask:0xf
    v_max_f32_dpp v15, v15, v15 quad_perm:[1,0,3,2] row_mask:0xf bank_mask:0xf
    s_nop 0
    v_max_f32_dpp v14, v14, v14 quad_perm:[2,3,0,1] row_mask:0xf bank_mask:0xf
    v_max_f32_dpp v15, v15, v15 quad_perm:[2,3,0,1] row_mask:0xf bank_mask:0xf
    s_nop 0
    v_max_f32_dpp v14, v14, v14 row_half_mirror row_mask:0xf bank_mask:0xf
    v_max_f32_dpp v15, v15, v15 row_half_mirror row_mask:0xf bank_mask:0xf
    s_nop 0
    v_max_f32_dpp v14, v14, v14 row_mirror row_mask:0xf bank_mask:0xf
    v_max_f32_dpp v15, v15, v15 row_mirror row_mask:0xf bank_mask:0xf
    s_nop 0
    v_max_f32_dpp v14, v14, v14 row_bcast:15 row_mask:0xa bank_mask:0xf
    v_max_f32_dpp v15, v15, v15 row_bcast:15 row_mask:0xa bank_mask:0xf
    s_nop 0
    v_max_f32_dpp v14, v14, v14 row_bcast:31 row_mask:0xc bank_mask:0xf
    v_max_f32_dpp v15, v15, v15 row_bcast:31 row_mask:0xc bank_mask:0xf
    s_nop 0
    v_readlane_b32 s46, v14, 63
    v_readlane_b32 s47, v15, 63
    s_nop 1
    v_subrev_f32 v12, s46, v12
    v_subrev_f32 v13, s47, v13
    s_mov_b64 exec, s[36:37]
    s_branch SC_EXP
ROLE_VALUE:
    v_lshlrev_b32 v4, 4, v0
    v_add_u32 v5, 4096, v4
    v_cmp_gt_u32 vcc, 192, v0
    s_nop 1
    v_cndmask_b32 v5, v4, v5, vcc
    v_and_b32 v7, 15, v2
    v_lshrrev_b32 v8, 4, v2
    v_mov_b32 v6, 0x4444
    v_mov_b32 v9, 0xeeee
    v_cmp_gt_u32 vcc, 8, v7
    s_nop 1
    v_cndmask_b32 v6, v9, v6, vcc
    v_and_b32 v9, 7, v7
    v_lshlrev_b32 v9, 4, v9
    v_lshl_add_u32 v9, v8, 7, v9
    s_lshl_b32 s24, s21, 2
    s_add_u32 s24, s24, s20
    s_mul_i32 s24, s24, 114688
    s_add_u32 s24, s24, 85983232
    s_add_u32 s28, s24, 0
    buffer_load_dwordx4 a[0:3], v3, s[8:11], s28 offen offset:0
    buffer_load_dwordx4 a[4:7], v3, s[8:11], s28 offen offset:1024
    buffer_load_dwordx4 a[8:11], v3, s[8:11], s28 offen offset:2048
    buffer_load_dwordx4 a[12:15], v3, s[8:11], s28 offen offset:3072
    s_add_u32 s28, s24, 4096
    buffer_load_dwordx4 a[16:19], v3, s[8:11], s28 offen offset:0
    buffer_load_dwordx4 a[20:23], v3, s[8:11], s28 offen offset:1024
    buffer_load_dwordx4 a[24:27], v3, s[8:11], s28 offen offset:2048
    buffer_load_dwordx4 a[28:31], v3, s[8:11], s28 offen offset:3072
    s_add_u32 s28, s24, 8192
    buffer_load_dwordx4 a[32:35], v3, s[8:11], s28 offen offset:0
    buffer_load_dwordx4 a[36:39], v3, s[8:11], s28 offen offset:1024
    buffer_load_dwordx4 a[40:43], v3, s[8:11], s28 offen offset:2048
    buffer_load_dwordx4 a[44:47], v3, s[8:11], s28 offen offset:3072
    s_add_u32 s28, s24, 12288
    buffer_load_dwordx4 a[48:51], v3, s[8:11], s28 offen offset:0
    buffer_load_dwordx4 a[52:55], v3, s[8:11], s28 offen offset:1024
    buffer_load_dwordx4 a[56:59], v3, s[8:11], s28 offen offset:2048
    buffer_load_dwordx4 a[60:63], v3, s[8:11], s28 offen offset:3072
    s_add_u32 s28, s24, 16384
    buffer_load_dwordx4 a[64:67], v3, s[8:11], s28 offen offset:0
    buffer_load_dwordx4 a[68:71], v3, s[8:11], s28 offen offset:1024
    buffer_load_dwordx4 a[72:75], v3, s[8:11], s28 offen offset:2048
    buffer_load_dwordx4 a[76:79], v3, s[8:11], s28 offen offset:3072
    s_add_u32 s28, s24, 20480
    buffer_load_dwordx4 a[80:83], v3, s[8:11], s28 offen offset:0
    buffer_load_dwordx4 a[84:87], v3, s[8:11], s28 offen offset:1024
    buffer_load_dwordx4 a[88:91], v3, s[8:11], s28 offen offset:2048
    buffer_load_dwordx4 a[92:95], v3, s[8:11], s28 offen offset:3072
    s_add_u32 s28, s24, 28672
    buffer_load_dwordx4 a[96:99], v3, s[8:11], s28 offen offset:0
    buffer_load_dwordx4 a[100:103], v3, s[8:11], s28 offen offset:1024
    buffer_load_dwordx4 a[104:107], v3, s[8:11], s28 offen offset:2048
    buffer_load_dwordx4 a[108:111], v3, s[8:11], s28 offen offset:3072
    s_add_u32 s28, s24, 32768
    buffer_load_dwordx4 a[112:115], v3, s[8:11], s28 offen offset:0
    buffer_load_dwordx4 a[116:119], v3, s[8:11], s28 offen offset:1024
    buffer_load_dwordx4 a[120:123], v3, s[8:11], s28 offen offset:2048
    buffer_load_dwordx4 a[124:127], v3, s[8:11], s28 offen offset:3072
    s_add_u32 s28, s24, 36864
    buffer_load_dwordx4 a[128:131], v3, s[8:11], s28 offen offset:0
    buffer_load_dwordx4 a[132:135], v3, s[8:11], s28 offen offset:1024
    buffer_load_dwordx4 a[136:139], v3, s[8:11], s28 offen offset:2048
    buffer_load_dwordx4 a[140:143], v3, s[8:11], s28 offen offset:3072
    s_add_u32 s28, s24, 40960
    buffer_load_dwordx4 a[144:147], v3, s[8:11], s28 offen offset:0
    buffer_load_dwordx4 a[148:151], v3, s[8:11], s28 offen offset:1024
    buffer_load_dwordx4 a[152:155], v3, s[8:11], s28 offen offset:2048
    buffer_load_dwordx4 a[156:159], v3, s[8:11], s28 offen offset:3072
    s_add_u32 s28, s24, 45056
    buffer_load_dwordx4 a[160:163], v3, s[8:11], s28 offen offset:0
    buffer_load_dwordx4 a[164:167], v3, s[8:11], s28 offen offset:1024
    buffer_load_dwordx4 a[168:171], v3, s[8:11], s28 offen offset:2048
    buffer_load_dwordx4 a[172:175], v3, s[8:11], s28 offen offset:3072
    s_add_u32 s28, s24, 49152
    buffer_load_dwordx4 a[176:179], v3, s[8:11], s28 offen offset:0
    buffer_load_dwordx4 a[180:183], v3, s[8:11], s28 offen offset:1024
    buffer_load_dwordx4 a[184:187], v3, s[8:11], s28 offen offset:2048
    buffer_load_dwordx4 a[188:191], v3, s[8:11], s28 offen offset:3072
    s_add_u32 s28, s24, 57344
    buffer_load_dwordx4 a[192:195], v3, s[8:11], s28 offen offset:0
    buffer_load_dwordx4 a[196:199], v3, s[8:11], s28 offen offset:1024
    buffer_load_dwordx4 a[200:203], v3, s[8:11], s28 offen offset:2048
    buffer_load_dwordx4 a[204:207], v3, s[8:11], s28 offen offset:3072
    s_add_u32 s28, s24, 61440
    buffer_load_dwordx4 a[208:211], v3, s[8:11], s28 offen offset:0
    buffer_load_dwordx4 a[212:215], v3, s[8:11], s28 offen offset:1024
    buffer_load_dwordx4 a[216:219], v3, s[8:11], s28 offen offset:2048
    buffer_load_dwordx4 a[220:223], v3, s[8:11], s28 offen offset:3072
    s_add_u32 s28, s24, 65536
    buffer_load_dwordx4 a[224:227], v3, s[8:11], s28 offen offset:0
    buffer_load_dwordx4 a[228:231], v3, s[8:11], s28 offen offset:1024
    buffer_load_dwordx4 a[232:235], v3, s[8:11], s28 offen offset:2048
    buffer_load_dwordx4 a[236:239], v3, s[8:11], s28 offen offset:3072
    s_add_u32 s28, s24, 69632
    buffer_load_dwordx4 a[240:243], v3, s[8:11], s28 offen offset:0
    buffer_load_dwordx4 a[244:247], v3, s[8:11], s28 offen offset:1024
    buffer_load_dwordx4 a[248:251], v3, s[8:11], s28 offen offset:2048
    buffer_load_dwordx4 a[252:255], v3, s[8:11], s28 offen offset:3072
    s_add_u32 s28, s24, 73728
    buffer_load_dwordx4 v[128:131], v3, s[8:11], s28 offen offset:0
    buffer_load_dwordx4 v[132:135], v3, s[8:11], s28 offen offset:1024
    buffer_load_dwordx4 v[136:139], v3, s[8:11], s28 offen offset:2048
    buffer_load_dwordx4 v[140:143], v3, s[8:11], s28 offen offset:3072
    s_add_u32 s28, s24, 77824
    buffer_load_dwordx4 v[144:147], v3, s[8:11], s28 offen offset:0
    buffer_load_dwordx4 v[148:151], v3, s[8:11], s28 offen offset:1024
    buffer_load_dwordx4 v[152:155], v3, s[8:11], s28 offen offset:2048
    buffer_load_dwordx4 v[156:159], v3, s[8:11], s28 offen offset:3072
    s_add_u32 s28, s24, 86016
    buffer_load_dwordx4 v[160:163], v3, s[8:11], s28 offen offset:0
    buffer_load_dwordx4 v[164:167], v3, s[8:11], s28 offen offset:1024
    buffer_load_dwordx4 v[168:171], v3, s[8:11], s28 offen offset:2048
    buffer_load_dwordx4 v[172:175], v3, s[8:11], s28 offen offset:3072
    s_add_u32 s28, s24, 90112
    buffer_load_dwordx4 v[176:179], v3, s[8:11], s28 offen offset:0
    buffer_load_dwordx4 v[180:183], v3, s[8:11], s28 offen offset:1024
    buffer_load_dwordx4 v[184:187], v3, s[8:11], s28 offen offset:2048
    buffer_load_dwordx4 v[188:191], v3, s[8:11], s28 offen offset:3072
    s_add_u32 s28, s24, 94208
    buffer_load_dwordx4 v[192:195], v3, s[8:11], s28 offen offset:0
    buffer_load_dwordx4 v[196:199], v3, s[8:11], s28 offen offset:1024
    buffer_load_dwordx4 v[200:203], v3, s[8:11], s28 offen offset:2048
    buffer_load_dwordx4 v[204:207], v3, s[8:11], s28 offen offset:3072
    s_add_u32 s28, s24, 98304
    buffer_load_dwordx4 v[208:211], v3, s[8:11], s28 offen offset:0
    buffer_load_dwordx4 v[212:215], v3, s[8:11], s28 offen offset:1024
    buffer_load_dwordx4 v[216:219], v3, s[8:11], s28 offen offset:2048
    buffer_load_dwordx4 v[220:223], v3, s[8:11], s28 offen offset:3072
    s_add_u32 s28, s24, 102400
    buffer_load_dwordx4 v[224:227], v3, s[8:11], s28 offen offset:0
    buffer_load_dwordx4 v[228:231], v3, s[8:11], s28 offen offset:1024
    buffer_load_dwordx4 v[232:235], v3, s[8:11], s28 offen offset:2048
    buffer_load_dwordx4 v[236:239], v3, s[8:11], s28 offen offset:3072
    s_add_u32 s28, s24, 106496
    buffer_load_dwordx4 v[240:243], v3, s[8:11], s28 offen offset:0
    buffer_load_dwordx4 v[244:247], v3, s[8:11], s28 offen offset:1024
    buffer_load_dwordx4 v[248:251], v3, s[8:11], s28 offen offset:2048
    buffer_load_dwordx4 v[252:255], v3, s[8:11], s28 offen offset:3072
    s_lshl_b32 s25, s20, 14
    s_add_u32 s25, s25, 16384
    s_add_u32 s28, s24, 24576
    s_add_u32 s29, s25, 0
    s_mov_b32 m0, s29
    s_nop 0
    buffer_load_dwordx4 v3, s[8:11], s28 offen offset:0 lds
    buffer_load_dwordx4 v3, s[8:11], s28 offen offset:1024 lds
    buffer_load_dwordx4 v3, s[8:11], s28 offen offset:2048 lds
    buffer_load_dwordx4 v3, s[8:11], s28 offen offset:3072 lds
    s_add_u32 s28, s24, 53248
    s_add_u32 s29, s25, 4096
    s_mov_b32 m0, s29
    s_nop 0
    buffer_load_dwordx4 v3, s[8:11], s28 offen offset:0 lds
    buffer_load_dwordx4 v3, s[8:11], s28 offen offset:1024 lds
    buffer_load_dwordx4 v3, s[8:11], s28 offen offset:2048 lds
    buffer_load_dwordx4 v3, s[8:11], s28 offen offset:3072 lds
    s_add_u32 s28, s24, 81920
    s_add_u32 s29, s25, 8192
    s_mov_b32 m0, s29
    s_nop 0
    buffer_load_dwordx4 v3, s[8:11], s28 offen offset:0 lds
    buffer_load_dwordx4 v3, s[8:11], s28 offen offset:1024 lds
    buffer_load_dwordx4 v3, s[8:11], s28 offen offset:2048 lds
    buffer_load_dwordx4 v3, s[8:11], s28 offen offset:3072 lds
    s_add_u32 s28, s24, 110592
    s_add_u32 s29, s25, 12288
    s_mov_b32 m0, s29
    s_nop 0
    buffer_load_dwordx4 v3, s[8:11], s28 offen offset:0 lds
    buffer_load_dwordx4 v3, s[8:11], s28 offen offset:1024 lds
    buffer_load_dwordx4 v3, s[8:11], s28 offen offset:2048 lds
    buffer_load_dwordx4 v3, s[8:11], s28 offen offset:3072 lds
    v_add_u32 v10, s25, v3
    v_mul_u32_u24 v11, 7168, v8
    v_lshl_add_u32 v11, v7, 4, v11
    v_lshrrev_b32 v12, 1, v8
    v_lshl_add_u32 v12, v12, 4, v7
    v_lshlrev_b32 v12, 5, v12
    v_and_b32 v13, 1, v8
    v_lshl_add_u32 v12, v13, 4, v12
    s_lshl_b32 s28, s20, 10
    s_add_u32 s28, s28, 8192
    v_add_u32 v124, s28, v12
    v_lshlrev_b32 v125, 2, v0
    v_add_u32 v125, 8192, v125
    v_lshrrev_b32 v12, 7, v0
    v_bfe_u32 v13, v0, 6, 1
    v_lshl_add_u32 v12, v12, 1, v13
    v_lshlrev_b32 v12, 3, v12
    v_and_b32 v13, 7, v0
    v_add_u32 v12, v12, v13
    v_lshlrev_b32 v12, 4, v12
    v_bfe_u32 v13, v0, 4, 2
    v_lshl_add_u32 v12, v13, 2, v12
    s_lshl_b32 s28, s21, 9
    v_add_u32 v126, s28, v12
    v_lshrrev_b32 v12, 1, v8
    v_mul_u32_u24 v12, 7168, v12
    v_lshl_add_u32 v12, v7, 4, v12
    v_and_b32 v13, 1, v8
    v_lshl_add_u32 v12, v13, 3, v12
    s_mul_i32 s28, s20, 28672
    s_lshl_b32 s29, s21, 9
    s_add_u32 s28, s28, s29
    v_add_u32 v127, s28, v12
    s_mov_b32 s36, 0x00ff00ff
    s_mov_b32 s37, 0x00ff00ff
    s_mov_b32 s30, 0
    s_mov_b32 s31, 30408704
    s_mul_i32 s32, s20, 3072
    s_add_u32 s32, s32, 31457280
    s_mul_i32 s33, s20, 114688
    s_lshl_b32 s28, s21, 9
    s_add_u32 s33, s33, s28
    s_add_u32 s33, s33, 33554432
    s_mov_b32 s35, 32505856
    s_mov_b32 s40, 62914560
    v_mov_b32 v1, 0
    v_mov_b32 v120, 0
    v_mov_b32 v28, 0
    v_mov_b32 v29, 0
    v_mov_b32 v30, 0
    v_mov_b32 v31, 0
    v_mov_b32 v32, 0
    v_mov_b32 v33, 0
    v_mov_b32 v34, 0
    v_mov_b32 v35, 0
    v_mov_b32 v36, 0
    v_mov_b32 v37, 0
    v_mov_b32 v38, 0
    v_mov_b32 v39, 0
    v_mov_b32 v40, 0
    v_mov_b32 v41, 0
    v_mov_b32 v42, 0
    v_mov_b32 v43, 0
    s_add_u32 s12, s4, 32555008
    s_addc_u32 s13, s5, 0
    s_mov_b32 s14, 4096
    s_mov_b32 s15, 0x00020000
    s_cmp_eq_u32 s48, 2
    s_cbranch_scc0 DME_17
    s_mov_b32 s34, 0
DM_16:
    s_mov_b32 s42, 32546816
    buffer_load_dword v121, v1, s[8:11], s42 offen sc1
    s_mov_b32 s42, 32547840
    buffer_load_dword v122, v1, s[8:11], s42 offen sc1
    s_add_u32 s34, s34, 1
    s_cmp_gt_u32 s34, 4194304
    s_cbranch_scc1 CH_ABORT
    s_waitcnt vmcnt(0)
    v_readfirstlane_b32 s45, v121
    v_readfirstlane_b32 s46, v122
    s_nop 3
    s_mov_b32 s48, 0
    s_cmp_ge_u32 s45, 30
    s_cbranch_scc1 DME_17
    s_cmp_lt_u32 s46, 256
    s_cbranch_scc1 DM_16
    s_mov_b32 s42, 32546816
    buffer_load_dword v121, v1, s[8:11], s42 offen sc1
    s_waitcnt vmcnt(0)
    v_readfirstlane_b32 s45, v121
    s_nop 3
    s_cmp_ge_u32 s45, 30
    s_cselect_b32 s48, 0, 1
DME_17:
    s_waitcnt vmcnt(0)
VA_LOOP:
    s_mov_b32 s34, 0
PLV_18:
    buffer_load_dwordx4 v[44:47], v4, s[8:11], s31 offen sc1
    buffer_load_dwordx4 v[48:51], v5, s[8:11], s31 offen sc1
    s_waitcnt vmcnt(0)
    v_max3_u32 v121, v44, v45, v46
    v_max3_u32 v122, v47, v48, v49
    v_max3_u32 v121, v121, v50, v51
    v_max_u32 v121, v121, v122
    v_cmp_eq_u32 vcc, -1, v121
    s_cbranch_vccz PDV_20
    s_add_u32 s34, s34, 1
    s_cmp_lt_u32 s34, 4194304
    s_cbranch_scc1 PLV_18
    s_branch CH_ABORT
PDV_20:
    ds_write_b128 v4, v[44:47]
    ds_write_b128 v5, v[48:51]
PEV_19:
    s_waitcnt lgkmcnt(0)
    s_barrier
    ds_read_b128 v[12:15], v9 offset:0
    ds_read_b128 v[16:19], v9 offset:512
    ds_read_b128 v[20:23], v9 offset:1024
    v_cmp_gt_u32 vcc, 16, v120
    s_cbranch_vccz VA_FOK1
    s_mov_b32 s34, 0
VA_WF1:
    buffer_load_dword v120, v1, s[8:11], s35 offen sc1
    s_add_u32 s34, s34, 1
    s_cmp_gt_u32 s34, 4194304
    s_cbranch_scc1 CH_ABORT
    s_waitcnt vmcnt(0)
    v_cmp_gt_u32 vcc, 16, v120
    s_cbranch_vccnz VA_WF1
VA_FOK1:
    s_add_u32 s28, s33, 0
    buffer_load_dwordx4 v[44:47], v11, s[8:11], s28 offen sc1
    s_add_u32 s28, s33, 28672
    buffer_load_dwordx4 v[48:51], v11, s[8:11], s28 offen sc1
    s_add_u32 s28, s33, 256
    buffer_load_dwordx4 v[52:55], v11, s[8:11], s28 offen sc1
    s_add_u32 s28, s33, 28928
    buffer_load_dwordx4 v[56:59], v11, s[8:11], s28 offen sc1
    s_add_u32 s28, s33, 57344
    buffer_load_dwordx4 v[60:63], v11, s[8:11], s28 offen sc1
    s_add_u32 s28, s33, 86016
    buffer_load_dwordx4 v[64:67], v11, s[8:11], s28 offen sc1
    s_add_u32 s28, s33, 57600
    buffer_load_dwordx4 v[68:71], v11, s[8:11], s28 offen sc1
    s_add_u32 s28, s33, 86272
    buffer_load_dwordx4 v[72:75], v11, s[8:11], s28 offen sc1
    buffer_load_dword v120, v1, s[8:11], s35 offen offset:128 sc1
    ds_read_b128 v[24:27], v9 offset:1536
    s_waitcnt lgkmcnt(3)
    v_smfmac_f32_16x16x64_bf16 v[28:31], v[12:15], a[0:7], v6
    v_smfmac_f32_16x16x64_bf16 v[32:35], v[12:15], a[96:103], v6
    v_smfmac_f32_16x16x64_bf16 v[36:39], v[12:15], a[192:199], v6
    v_smfmac_f32_16x16x64_bf16 v[40:43], v[12:15], v[160:167], v6
    ds_read_b128 v[12:15], v9 offset:2048
    s_waitcnt lgkmcnt(3)
    v_smfmac_f32_16x16x64_bf16 v[28:31], v[16:19], a[8:15], v6
    v_smfmac_f32_16x16x64_bf16 v[32:35], v[16:19], a[104:111], v6
    v_smfmac_f32_16x16x64_bf16 v[36:39], v[16:19], a[200:207], v6
    v_smfmac_f32_16x16x64_bf16 v[40:43], v[16:19], v[168:175], v6
    s_cmp_eq_u32 s30, 0
    s_cbranch_scc1 DF_21
    s_add_u32 s28, s40, 0
    buffer_store_dwordx2 v[112:113], v127, s[8:11], s28 offen sc1
    s_add_u32 s28, s40, 14336
    buffer_store_dwordx2 v[114:115], v127, s[8:11], s28 offen sc1
    s_add_u32 s28, s40, 256
    buffer_store_dwordx2 v[116:117], v127, s[8:11], s28 offen sc1
    s_add_u32 s28, s40, 14592
    buffer_store_dwordx2 v[118:119], v127, s[8:11], s28 offen sc1
    s_add_u32 s40, s40, 114688
    s_add_u32 s28, s31, 524288
    s_mov_b64 exec, s[36:37]
    buffer_store_dword v100, v126, s[8:11], s28 offen sc1
    s_mov_b64 exec, -1
    s_cmp_eq_u32 s20, 0
    s_cbranch_scc0 WA_22
    s_mov_b64 exec, 1
    v_mov_b32 v123, 1
    s_add_u32 s28, s35, 32640
    buffer_atomic_add v123, v1, s[8:11], s28 offen
    s_mov_b64 exec, -1
WA_22:
DF_21:
    ds_read_b128 v[16:19], v9 offset:2560
    s_waitcnt lgkmcnt(3)
    v_smfmac_f32_16x16x64_bf16 v[28:31], v[20:23], a[16:23], v6
    v_smfmac_f32_16x16x64_bf16 v[32:35], v[20:23], a[112:119], v6
    v_smfmac_f32_16x16x64_bf16 v[36:39], v[20:23], a[208:215], v6
    v_smfmac_f32_16x16x64_bf16 v[40:43], v[20:23], v[176:183], v6
    ds_read_b128 v[20:23], v9 offset:3072
    s_waitcnt lgkmcnt(3)
    v_smfmac_f32_16x16x64_bf16 v[28:31], v[24:27], a[24:31], v6
    v_smfmac_f32_16x16x64_bf16 v[32:35], v[24:27], a[120:127], v6
    v_smfmac_f32_16x16x64_bf16 v[36:39], v[24:27], a[216:223], v6
    v_smfmac_f32_16x16x64_bf16 v[40:43], v[24:27], v[184:191], v6
    ds_read_b128 v[24:27], v9 offset:3584
    s_waitcnt lgkmcnt(3)
    v_smfmac_f32_16x16x64_bf16 v[28:31], v[12:15], a[32:39], v6
    v_smfmac_f32_16x16x64_bf16 v[32:35], v[12:15], a[128:135], v6
    v_smfmac_f32_16x16x64_bf16 v[36:39], v[12:15], a[224:231], v6
    v_smfmac_f32_16x16x64_bf16 v[40:43], v[12:15], v[192:199], v6
    ds_read_b128 v[12:15], v9 offset:4096
    s_waitcnt lgkmcnt(3)
    v_smfmac_f32_16x16x64_bf16 v[28:31], v[16:19], a[40:47], v6
    v_smfmac_f32_16x16x64_bf16 v[32:35], v[16:19], a[136:143], v6
    v_smfmac_f32_16x16x64_bf16 v[36:39], v[16:19], a[232:239], v6
    v_smfmac_f32_16x16x64_bf16 v[40:43], v[16:19], v[200:207], v6
    ds_read_b128 v[16:19], v9 offset:4608
    s_waitcnt lgkmcnt(3)
    v_smfmac_f32_16x16x64_bf16 v[28:31], v[20:23], a[48:55], v6
    v_smfmac_f32_16x16x64_bf16 v[32:35], v[20:23], a[144:151], v6
    v_smfmac_f32_16x16x64_bf16 v[36:39], v[20:23], a[240:247], v6
    v_smfmac_f32_16x16x64_bf16 v[40:43], v[20:23], v[208:215], v6
    ds_read_b128 v[20:23], v9 offset:5120
    s_waitcnt lgkmcnt(3)
    v_smfmac_f32_16x16x64_bf16 v[28:31], v[24:27], a[56:63], v6
    v_smfmac_f32_16x16x64_bf16 v[32:35], v[24:27], a[152:159], v6
    v_smfmac_f32_16x16x64_bf16 v[36:39], v[24:27], a[248:255], v6
    v_smfmac_f32_16x16x64_bf16 v[40:43], v[24:27], v[216:223], v6
    ds_read_b128 v[24:27], v9 offset:5632
    s_waitcnt lgkmcnt(3)
    v_smfmac_f32_16x16x64_bf16 v[28:31], v[12:15], a[64:71], v6
    v_smfmac_f32_16x16x64_bf16 v[32:35], v[12:15], a[160:167], v6
    v_smfmac_f32_16x16x64_bf16 v[36:39], v[12:15], v[128:135], v6
    v_smfmac_f32_16x16x64_bf16 v[40:43], v[12:15], v[224:231], v6
    ds_read_b128 v[12:15], v9 offset:6144
    s_waitcnt lgkmcnt(3)
    v_smfmac_f32_16x16x64_bf16 v[28:31], v[16:19], a[72:79], v6
    v_smfmac_f32_16x16x64_bf16 v[32:35], v[16:19], a[168:175], v6
    v_smfmac_f32_16x16x64_bf16 v[36:39], v[16:19], v[136:143], v6
    v_smfmac_f32_16x16x64_bf16 v[40:43], v[16:19], v[232:239], v6
    ds_read_b128 v[16:19], v9 offset:6656
    s_waitcnt lgkmcnt(3)
    v_smfmac_f32_16x16x64_bf16 v[28:31], v[20:23], a[80:87], v6
    v_smfmac_f32_16x16x64_bf16 v[32:35], v[20:23], a[176:183], v6
    v_smfmac_f32_16x16x64_bf16 v[36:39], v[20:23], v[144:151], v6
    v_smfmac_f32_16x16x64_bf16 v[40:43], v[20:23], v[240:247], v6
    ds_read_b128 v[76:79], v10 offset:0
    ds_read_b128 v[80:83], v10 offset:1024
    ds_read_b128 v[84:87], v10 offset:4096
    ds_read_b128 v[88:91], v10 offset:5120
    s_waitcnt lgkmcnt(6)
    v_smfmac_f32_16x16x64_bf16 v[28:31], v[24:27], a[88:95], v6
    v_smfmac_f32_16x16x64_bf16 v[32:35], v[24:27], a[184:191], v6
    v_smfmac_f32_16x16x64_bf16 v[36:39], v[24:27], v[152:159], v6
    v_smfmac_f32_16x16x64_bf16 v[40:43], v[24:27], v[248:255], v6
    s_waitcnt lgkmcnt(5)
    s_waitcnt lgkmcnt(2)
    v_smfmac_f32_16x16x64_bf16 v[28:31], v[12:15], v[76:83], v6
    ds_read_b128 v[76:79], v10 offset:8192
    ds_read_b128 v[80:83], v10 offset:9216
    s_waitcnt lgkmcnt(2)
    v_smfmac_f32_16x16x64_bf16 v[32:35], v[12:15], v[84:91], v6
    ds_read_b128 v[84:87], v10 offset:12288
    ds_read_b128 v[88:91], v10 offset:13312
    s_waitcnt lgkmcnt(2)
    v_smfmac_f32_16x16x64_bf16 v[36:39], v[12:15], v[76:83], v6
    ds_read_b128 v[76:79], v10 offset:2048
    ds_read_b128 v[80:83], v10 offset:3072
    s_waitcnt lgkmcnt(2)
    v_smfmac_f32_16x16x64_bf16 v[40:43], v[12:15], v[84:91], v6
    ds_read_b128 v[84:87], v10 offset:6144
    ds_read_b128 v[88:91], v10 offset:7168
    s_waitcnt lgkmcnt(2)
    v_smfmac_f32_16x16x64_bf16 v[28:31], v[16:19], v[76:83], v6
    ds_read_b128 v[76:79], v10 offset:10240
    ds_read_b128 v[80:83], v10 offset:11264
    s_waitcnt lgkmcnt(2)
    v_smfmac_f32_16x16x64_bf16 v[32:35], v[16:19], v[84:91], v6
    ds_read_b128 v[84:87], v10 offset:14336
    ds_read_b128 v[88:91], v10 offset:15360
    s_waitcnt lgkmcnt(2)
    v_smfmac_f32_16x16x64_bf16 v[36:39], v[16:19], v[76:83], v6
    s_waitcnt lgkmcnt(0)
    v_smfmac_f32_16x16x64_bf16 v[40:43], v[16:19], v[84:91], v6
    s_nop 6
    v_cvt_pk_bf16_f32 v112, v28, v29
    v_cvt_pk_bf16_f32 v113, v30, v31
    v_cvt_pk_bf16_f32 v114, v32, v33
    v_cvt_pk_bf16_f32 v115, v34, v35
    v_cvt_pk_bf16_f32 v116, v36, v37
    v_cvt_pk_bf16_f32 v117, v38, v39
    v_cvt_pk_bf16_f32 v118, v40, v41
    v_cvt_pk_bf16_f32 v119, v42, v43
    s_cmp_eq_u32 s30, 63
    s_cbranch_scc1 VA_END
    s_mov_b32 s34, 0
PLP_23:
    buffer_load_dwordx4 v[76:79], v3, s[8:11], s32 offen sc1
    buffer_load_dwordx4 v[80:83], v3, s[8:11], s32 offen offset:1024 sc1
    buffer_load_dwordx4 v[84:87], v3, s[8:11], s32 offen offset:2048 sc1
    s_waitcnt vmcnt(0)
    v_max3_u32 v12, v76, v77, v78
    v_max3_u32 v13, v79, v80, v81
    v_max3_u32 v14, v82, v83, v84
    v_max3_u32 v15, v85, v86, v87
    v_max3_u32 v12, v12, v13, v14
    v_max_u32 v12, v12, v15
    v_cmp_eq_u32 vcc, -1, v12
    s_cbranch_vccz PDP_25
    s_add_u32 s34, s34, 1
    s_cmp_lt_u32 s34, 4194304
    s_cbranch_scc1 PLP_23
    s_branch CH_ABORT
PDP_25:
    v_mfma_f32_16x16x32_bf16 v[28:31], v[84:87], v[112:115], 0
    v_mfma_f32_16x16x32_bf16 v[32:35], v[84:87], v[116:119], 0
    v_smfmac_f32_16x16x64_bf16 v[28:31], v[76:79], v[44:51], v6
    v_smfmac_f32_16x16x64_bf16 v[32:35], v[76:79], v[52:59], v6
    v_smfmac_f32_16x16x64_bf16 v[28:31], v[80:83], v[60:67], v6
    v_smfmac_f32_16x16x64_bf16 v[32:35], v[80:83], v[68:75], v6
PEP_24:
    s_add_u32 s31, s31, 7168
    s_add_u32 s30, s30, 1
    s_add_u32 s32, s32, 12288
    s_add_u32 s33, s33, 458752
    s_add_u32 s35, s35, 128
    s_nop 4
    v_permlane32_swap_b32 v28, v32
    v_permlane32_swap_b32 v29, v33
    v_permlane32_swap_b32 v30, v34
    v_permlane32_swap_b32 v31, v35
    s_nop 0
    v_add_f32 v28, v28, v32
    v_add_f32 v29, v29, v33
    v_add_f32 v30, v30, v34
    v_add_f32 v31, v31, v35
    ds_write_b128 v124, v[28:31]
    s_waitcnt lgkmcnt(0)
    s_barrier
    ds_read2st64_b32 v[12:13], v125 offset0:0 offset1:4
    ds_read2st64_b32 v[14:15], v125 offset0:8 offset1:12
    s_waitcnt lgkmcnt(0)
    v_pk_add_f32 v[12:13], v[12:13], v[14:15]
    s_nop 0
    v_add_f32 v12, v12, v13
    s_nop 1
    v_mov_b32_dpp v13, v12 row_shl:8 row_mask:0xf bank_mask:0xf
    s_mov_b64 exec, s[36:37]
    v_cvt_pk_bf16_f32 v12, v12, v13
    v_min_u32 v100, 0xfffffffe, v12
    s_cmp_eq_u32 s48, 0
    s_cbranch_scc0 SM_26
    buffer_store_dword v100, v126, s[8:11], s31 offen
    s_branch SME_27
SM_26:
    buffer_store_dword v100, v126, s[8:11], s31 offen sc1
SME_27:
    s_mov_b64 exec, -1
    s_cmp_eq_u32 s30, 63
    s_cbranch_scc0 VA_NOEARLY
    s_add_u32 s28, s31, 524288
    s_mov_b64 exec, s[36:37]
    buffer_store_dword v100, v126, s[8:11], s28 offen sc1
    s_mov_b64 exec, -1
    s_waitcnt vmcnt(0)
    s_barrier
    s_cmp_eq_u32 s20, 0
    s_cbranch_scc0 VA_NOEARLY
    s_mov_b64 exec, 1
    v_mov_b32 v123, 1
    s_mov_b32 s28, 32548864
    buffer_atomic_add v123, v1, s[8:11], s28 offen
    s_mov_b64 exec, -1
VA_NOEARLY:
    v_mov_b32 v28, 0
    v_mov_b32 v29, 0
    v_mov_b32 v30, 0
    v_mov_b32 v31, 0
    v_mov_b32 v32, 0
    v_mov_b32 v33, 0
    v_mov_b32 v34, 0
    v_mov_b32 v35, 0
    v_mov_b32 v36, 0
    v_mov_b32 v37, 0
    v_mov_b32 v38, 0
    v_mov_b32 v39, 0
    v_mov_b32 v40, 0
    v_mov_b32 v41, 0
    v_mov_b32 v42, 0
    v_mov_b32 v43, 0
    s_branch VA_LOOP
VA_END:
    s_add_u32 s28, s40, 0
    buffer_store_dwordx2 v[112:113], v127, s[8:11], s28 offen sc1
    s_add_u32 s28, s40, 14336
    buffer_store_dwordx2 v[114:115], v127, s[8:11], s28 offen sc1
    s_add_u32 s28, s40, 256
    buffer_store_dwordx2 v[116:117], v127, s[8:11], s28 offen sc1
    s_add_u32 s28, s40, 14592
    buffer_store_dwordx2 v[118:119], v127, s[8:11], s28 offen sc1
    s_waitcnt vmcnt(0)
    s_barrier
    s_cmp_eq_u32 s20, 0
    s_cbranch_scc0 WA_28
    s_mov_b64 exec, 1
    v_mov_b32 v123, 1
    s_add_u32 s28, s35, 32768
    buffer_atomic_add v123, v1, s[8:11], s28 offen
    s_mov_b64 exec, -1
WA_28:
    s_cmp_eq_u32 s20, 0
    s_cbranch_scc0 WA_29
    s_mov_b64 exec, 1
    v_mov_b32 v123, 1
    s_add_u32 s28, s35, 32896
    buffer_atomic_add v123, v1, s[8:11], s28 offen
    s_mov_b64 exec, -1
WA_29:
    s_endpgm
CH_ABORT:
    s_endpgm
ROLE_HELP:
    s_add_u32 s12, s4, 32555008
    s_addc_u32 s13, s5, 0
    s_mov_b32 s14, 4096
    s_mov_b32 s15, 0x00020000
    v_mov_b32 v1, 0
    v_lshlrev_b32 v4, 4, v0
    s_mov_b32 s30, 0
HP_LOOP:
    s_mov_b32 s34, 0
HP_W:
    buffer_load_dword v5, v1, s[12:15], 0 offen offset:128 sc1
    s_lshl_b32 s32, s30, 7
    s_add_u32 s32, s32, 32505856
    buffer_load_dword v6, v1, s[8:11], s32 offen sc1
    s_add_u32 s34, s34, 1
    s_cmp_gt_u32 s34, 4194304
    s_cbranch_scc1 CH_ABORT
    s_waitcnt vmcnt(0)
    v_readfirstlane_b32 s31, v5
    v_readfirstlane_b32 s33, v6
    s_nop 3
    s_add_u32 s31, s31, 3
    s_cmp_le_u32 s30, s31
    s_cbranch_scc0 HP_SL
    s_cmp_ge_u32 s33, 16
    s_cbranch_scc1 HP_GO
HP_SL:
    s_sleep 4
    s_branch HP_W
HP_GO:
    s_mul_i32 s32, s30, 458752
    s_mul_i32 s33, s21, 229376
    s_add_u32 s32, s32, s33
    s_add_u32 s32, s32, 33554432
    s_cmp_eq_u32 s21, 0
    s_cbranch_scc0 HP_1
    s_mul_i32 s32, s30, 28672
    s_add_u32 s33, s32, 28672
    buffer_load_dwordx4 v[40:43], v4, s[8:11], s33 offen
    s_add_u32 s33, s32, 32768
    buffer_load_dwordx4 v[44:47], v4, s[8:11], s33 offen
    s_add_u32 s33, s32, 36864
    buffer_load_dwordx4 v[48:51], v4, s[8:11], s33 offen
    s_add_u32 s33, s32, 40960
    buffer_load_dwordx4 v[52:55], v4, s[8:11], s33 offen
    s_add_u32 s33, s32, 45056
    buffer_load_dwordx4 v[56:59], v4, s[8:11], s33 offen
    s_add_u32 s33, s32, 49152
    buffer_load_dwordx4 v[60:63], v4, s[8:11], s33 offen
    s_add_u32 s33, s32, 53248
    buffer_load_dwordx4 v[64:67], v4, s[8:11], s33 offen
    s_branch HP_N
HP_1:
    s_mul_i32 s32, s30, 12288
    s_add_u32 s33, s32, 31457280
    buffer_load_dwordx4 v[40:43], v4, s[8:11], s33 offen
    s_add_u32 s33, s32, 31461376
    buffer_load_dwordx4 v[44:47], v4, s[8:11], s33 offen
    s_add_u32 s33, s32, 31465472
    buffer_load_dwordx4 v[48:51], v4, s[8:11], s33 offen
    s_mul_i32 s32, s30, 7168
    s_add_u32 s33, s32, 30415872
    buffer_load_dwordx4 v[52:55], v4, s[8:11], s33 offen
    s_add_u32 s33, s32, 30419968
    buffer_load_dwordx4 v[56:59], v4, s[8:11], s33 offen
HP_N:
    s_add_u32 s30, s30, 1
    s_cmp_lt_u32 s30, 63
    s_cbranch_scc1 HP_LOOP
    s_waitcnt vmcnt(0)
    s_endpgm
ROLE_W2:
    v_mov_b32 v6, 0
    s_mov_b32 s29, 32505856
    s_mov_b32 s34, 0
WF_30:
    buffer_load_dword v11, v6, s[8:11], s29 offen sc1
    s_add_u32 s34, s34, 1
    s_cmp_gt_u32 s34, 4194304
    s_cbranch_scc1 TK_ABORT
    s_waitcnt vmcnt(0)
    v_cmp_gt_u32 vcc, 16, v11
    s_cbranch_vccnz WF_30
    s_mul_i32 s24, s21, 28
    s_mul_i32 s25, s20, 7
    s_add_u32 s24, s24, s25
    s_mul_i32 s24, s24, 14336
    s_add_u32 s24, s24, 2097152
    s_mul_i32 s26, s20, 7168
    s_mul_i32 s27, s22, 28672
    s_add_u32 s27, s27, s26
    s_mov_b32 m0, s26
    s_nop 0
    buffer_load_dwordx4 v3, s[8:11], s27 offen offset:0  lds
    buffer_load_dwordx4 v3, s[8:11], s27 offen offset:1024  lds
    buffer_load_dwordx4 v3, s[8:11], s27 offen offset:2048  lds
    buffer_load_dwordx4 v3, s[8:11], s27 offen offset:3072  lds
    s_add_u32 s28, s26, 4096
    s_add_u32 s29, s27, 4096
    s_mov_b32 m0, s28
    s_nop 0
    buffer_load_dwordx4 v3, s[8:11], s29 offen offset:0  lds
    buffer_load_dwordx4 v3, s[8:11], s29 offen offset:1024  lds
    buffer_load_dwordx4 v3, s[8:11], s29 offen offset:2048  lds
    s_add_u32 s25, s24, 0
    buffer_load_dwordx4 a[0:3], v3, s[8:11], s25 offen offset:0
    buffer_load_dwordx4 a[4:7], v3, s[8:11], s25 offen offset:1024
    buffer_load_dwordx4 a[8:11], v3, s[8:11], s25 offen offset:2048
    buffer_load_dwordx4 a[12:15], v3, s[8:11], s25 offen offset:3072
    s_add_u32 s25, s24, 4096
    buffer_load_dwordx4 a[16:19], v3, s[8:11], s25 offen offset:0
    buffer_load_dwordx4 a[20:23], v3, s[8:11], s25 offen offset:1024
    buffer_load_dwordx4 a[24:27], v3, s[8:11], s25 offen offset:2048
    buffer_load_dwordx4 a[28:31], v3, s[8:11], s25 offen offset:3072
    s_add_u32 s25, s24, 8192
    buffer_load_dwordx4 a[32:35], v3, s[8:11], s25 offen offset:0
    buffer_load_dwordx4 a[36:39], v3, s[8:11], s25 offen offset:1024
    buffer_load_dwordx4 a[40:43], v3, s[8:11], s25 offen offset:2048
    buffer_load_dwordx4 a[44:47], v3, s[8:11], s25 offen offset:3072
    s_add_u32 s25, s24, 12288
    buffer_load_dwordx4 a[48:51], v3, s[8:11], s25 offen offset:0
    buffer_load_dwordx4 a[52:55], v3, s[8:11], s25 offen offset:1024
    buffer_load_dwordx4 a[56:59], v3, s[8:11], s25 offen offset:2048
    buffer_load_dwordx4 a[60:63], v3, s[8:11], s25 offen offset:3072
    s_add_u32 s25, s24, 16384
    buffer_load_dwordx4 a[64:67], v3, s[8:11], s25 offen offset:0
    buffer_load_dwordx4 a[68:71], v3, s[8:11], s25 offen offset:1024
    buffer_load_dwordx4 a[72:75], v3, s[8:11], s25 offen offset:2048
    buffer_load_dwordx4 a[76:79], v3, s[8:11], s25 offen offset:3072
    s_add_u32 s25, s24, 20480
    buffer_load_dwordx4 a[80:83], v3, s[8:11], s25 offen offset:0
    buffer_load_dwordx4 a[84:87], v3, s[8:11], s25 offen offset:1024
    buffer_load_dwordx4 a[88:91], v3, s[8:11], s25 offen offset:2048
    buffer_load_dwordx4 a[92:95], v3, s[8:11], s25 offen offset:3072
    s_add_u32 s25, s24, 24576
    buffer_load_dwordx4 a[96:99], v3, s[8:11], s25 offen offset:0
    buffer_load_dwordx4 a[100:103], v3, s[8:11], s25 offen offset:1024
    buffer_load_dwordx4 a[104:107], v3, s[8:11], s25 offen offset:2048
    buffer_load_dwordx4 a[108:111], v3, s[8:11], s25 offen offset:3072
    s_add_u32 s25, s24, 28672
    buffer_load_dwordx4 a[112:115], v3, s[8:11], s25 offen offset:0
    buffer_load_dwordx4 a[116:119], v3, s[8:11], s25 offen offset:1024
    buffer_load_dwordx4 a[120:123], v3, s[8:11], s25 offen offset:2048
    buffer_load_dwordx4 a[124:127], v3, s[8:11], s25 offen offset:3072
    s_add_u32 s25, s24, 32768
    buffer_load_dwordx4 a[128:131], v3, s[8:11], s25 offen offset:0
    buffer_load_dwordx4 a[132:135], v3, s[8:11], s25 offen offset:1024
    buffer_load_dwordx4 a[136:139], v3, s[8:11], s25 offen offset:2048
    buffer_load_dwordx4 a[140:143], v3, s[8:11], s25 offen offset:3072
    s_add_u32 s25, s24, 36864
    buffer_load_dwordx4 a[144:147], v3, s[8:11], s25 offen offset:0
    buffer_load_dwordx4 a[148:151], v3, s[8:11], s25 offen offset:1024
    buffer_load_dwordx4 a[152:155], v3, s[8:11], s25 offen offset:2048
    buffer_load_dwordx4 a[156:159], v3, s[8:11], s25 offen offset:3072
    s_add_u32 s25, s24, 40960
    buffer_load_dwordx4 a[160:163], v3, s[8:11], s25 offen offset:0
    buffer_load_dwordx4 a[164:167], v3, s[8:11], s25 offen offset:1024
    buffer_load_dwordx4 a[168:171], v3, s[8:11], s25 offen offset:2048
    buffer_load_dwordx4 a[172:175], v3, s[8:11], s25 offen offset:3072
    s_add_u32 s25, s24, 45056
    buffer_load_dwordx4 a[176:179], v3, s[8:11], s25 offen offset:0
    buffer_load_dwordx4 a[180:183], v3, s[8:11], s25 offen offset:1024
    buffer_load_dwordx4 a[184:187], v3, s[8:11], s25 offen offset:2048
    buffer_load_dwordx4 a[188:191], v3, s[8:11], s25 offen offset:3072
    s_add_u32 s25, s24, 49152
    buffer_load_dwordx4 a[192:195], v3, s[8:11], s25 offen offset:0
    buffer_load_dwordx4 a[196:199], v3, s[8:11], s25 offen offset:1024
    buffer_load_dwordx4 a[200:203], v3, s[8:11], s25 offen offset:2048
    buffer_load_dwordx4 a[204:207], v3, s[8:11], s25 offen offset:3072
    s_add_u32 s25, s24, 53248
    buffer_load_dwordx4 a[208:211], v3, s[8:11], s25 offen offset:0
    buffer_load_dwordx4 a[212:215], v3, s[8:11], s25 offen offset:1024
    buffer_load_dwordx4 a[216:219], v3, s[8:11], s25 offen offset:2048
    buffer_load_dwordx4 a[220:223], v3, s[8:11], s25 offen offset:3072
    s_add_u32 s25, s24, 57344
    buffer_load_dwordx4 a[224:227], v3, s[8:11], s25 offen offset:0
    buffer_load_dwordx4 a[228:231], v3, s[8:11], s25 offen offset:1024
    buffer_load_dwordx4 a[232:235], v3, s[8:11], s25 offen offset:2048
    buffer_load_dwordx4 a[236:239], v3, s[8:11], s25 offen offset:3072
    s_add_u32 s25, s24, 61440
    buffer_load_dwordx4 a[240:243], v3, s[8:11], s25 offen offset:0
    buffer_load_dwordx4 a[244:247], v3, s[8:11], s25 offen offset:1024
    buffer_load_dwordx4 a[248:251], v3, s[8:11], s25 offen offset:2048
    buffer_load_dwordx4 a[252:255], v3, s[8:11], s25 offen offset:3072
    s_add_u32 s25, s24, 65536
    buffer_load_dwordx4 v[120:123], v3, s[8:11], s25 offen offset:0
    buffer_load_dwordx4 v[124:127], v3, s[8:11], s25 offen offset:1024
    buffer_load_dwordx4 v[128:131], v3, s[8:11], s25 offen offset:2048
    buffer_load_dwordx4 v[132:135], v3, s[8:11], s25 offen offset:3072
    s_add_u32 s25, s24, 69632
    buffer_load_dwordx4 v[136:139], v3, s[8:11], s25 offen offset:0
    buffer_load_dwordx4 v[140:143], v3, s[8:11], s25 offen offset:1024
    buffer_load_dwordx4 v[144:147], v3, s[8:11], s25 offen offset:2048
    buffer_load_dwordx4 v[148:151], v3, s[8:11], s25 offen offset:3072
    s_add_u32 s25, s24, 73728
    buffer_load_dwordx4 v[152:155], v3, s[8:11], s25 offen offset:0
    buffer_load_dwordx4 v[156:159], v3, s[8:11], s25 offen offset:1024
    buffer_load_dwordx4 v[160:163], v3, s[8:11], s25 offen offset:2048
    buffer_load_dwordx4 v[164:167], v3, s[8:11], s25 offen offset:3072
    s_add_u32 s25, s24, 77824
    buffer_load_dwordx4 v[168:171], v3, s[8:11], s25 offen offset:0
    buffer_load_dwordx4 v[172:175], v3, s[8:11], s25 offen offset:1024
    buffer_load_dwordx4 v[176:179], v3, s[8:11], s25 offen offset:2048
    buffer_load_dwordx4 v[180:183], v3, s[8:11], s25 offen offset:3072
    s_add_u32 s25, s24, 81920
    buffer_load_dwordx4 v[184:187], v3, s[8:11], s25 offen offset:0
    buffer_load_dwordx4 v[188:191], v3, s[8:11], s25 offen offset:1024
    buffer_load_dwordx4 v[192:195], v3, s[8:11], s25 offen offset:2048
    buffer_load_dwordx4 v[196:199], v3, s[8:11], s25 offen offset:3072
    s_add_u32 s25, s24, 86016
    buffer_load_dwordx4 v[200:203], v3, s[8:11], s25 offen offset:0
    buffer_load_dwordx4 v[204:207], v3, s[8:11], s25 offen offset:1024
    buffer_load_dwordx4 v[208:211], v3, s[8:11], s25 offen offset:2048
    buffer_load_dwordx4 v[212:215], v3, s[8:11], s25 offen offset:3072
    s_add_u32 s25, s24, 90112
    buffer_load_dwordx4 v[216:219], v3, s[8:11], s25 offen offset:0
    buffer_load_dwordx4 v[220:223], v3, s[8:11], s25 offen offset:1024
    buffer_load_dwordx4 v[224:227], v3, s[8:11], s25 offen offset:2048
    buffer_load_dwordx4 v[228:231], v3, s[8:11], s25 offen offset:3072
    s_add_u32 s25, s24, 94208
    buffer_load_dwordx4 v[232:235], v3, s[8:11], s25 offen offset:0
    buffer_load_dwordx4 v[236:239], v3, s[8:11], s25 offen offset:1024
    buffer_load_dwordx4 v[240:243], v3, s[8:11], s25 offen offset:2048
    buffer_load_dwordx4 v[244:247], v3, s[8:11], s25 offen offset:3072
    s_add_u32 s25, s24, 98304
    buffer_load_dwordx4 v[248:251], v3, s[8:11], s25 offen offset:0
    buffer_load_dwordx4 v[252:255], v3, s[8:11], s25 offen offset:1024
    v_and_b32 v4, 15, v2
    v_lshrrev_b32 v5, 4, v2
    v_mov_b32 v6, 0
    v_mov_b32 v7, 1
    s_mul_i32 s27, s20, 14
    v_lshrrev_b32 v8, 1, v5
    v_add_u32 v8, s27, v8
    v_and_b32 v9, 1, v5
    v_lshlrev_b32 v9, 3, v9
    v_and_b32 v10, 7, v4
    v_lshl_add_u32 v10, v10, 4, v9
    v_lshl_add_u32 v9, v4, 4, v9
W2_LOOP:
    s_waitcnt vmcnt(0)
    s_barrier
    ds_read_b128 v[12:15], v3 offset:0
    ds_read_b128 v[16:19], v3 offset:1024
    ds_read_b128 v[20:23], v3 offset:2048
    ds_read_b128 v[24:27], v3 offset:3072
    s_waitcnt lgkmcnt(2)
    v_mfma_f32_16x16x32_bf16 v[28:31], a[0:3], v[12:15], 0
    v_mfma_f32_16x16x32_bf16 v[32:35], a[0:3], v[16:19], 0
    v_mfma_f32_16x16x32_bf16 v[36:39], a[56:59], v[12:15], 0
    v_mfma_f32_16x16x32_bf16 v[40:43], a[56:59], v[16:19], 0
    v_mfma_f32_16x16x32_bf16 v[44:47], a[112:115], v[12:15], 0
    v_mfma_f32_16x16x32_bf16 v[48:51], a[112:115], v[16:19], 0
    v_mfma_f32_16x16x32_bf16 v[52:55], a[168:171], v[12:15], 0
    v_mfma_f32_16x16x32_bf16 v[56:59], a[168:171], v[16:19], 0
    v_mfma_f32_16x16x32_bf16 v[60:63], a[224:227], v[12:15], 0
    v_mfma_f32_16x16x32_bf16 v[64:67], a[224:227], v[16:19], 0
    v_mfma_f32_16x16x32_bf16 v[68:71], v[144:147], v[12:15], 0
    v_mfma_f32_16x16x32_bf16 v[72:75], v[144:147], v[16:19], 0
    v_mfma_f32_16x16x32_bf16 v[76:79], v[200:203], v[12:15], 0
    v_mfma_f32_16x16x32_bf16 v[80:83], v[200:203], v[16:19], 0
    ds_read_b128 v[12:15], v3 offset:4096
    ds_read_b128 v[16:19], v3 offset:5120
    s_waitcnt lgkmcnt(2)
    v_mfma_f32_16x16x32_bf16 v[28:31], a[4:7], v[20:23], v[28:31]
    v_mfma_f32_16x16x32_bf16 v[32:35], a[4:7], v[24:27], v[32:35]
    v_mfma_f32_16x16x32_bf16 v[36:39], a[60:63], v[20:23], v[36:39]
    v_mfma_f32_16x16x32_bf16 v[40:43], a[60:63], v[24:27], v[40:43]
    v_mfma_f32_16x16x32_bf16 v[44:47], a[116:119], v[20:23], v[44:47]
    v_mfma_f32_16x16x32_bf16 v[48:51], a[116:119], v[24:27], v[48:51]
    v_mfma_f32_16x16x32_bf16 v[52:55], a[172:175], v[20:23], v[52:55]
    v_mfma_f32_16x16x32_bf16 v[56:59], a[172:175], v[24:27], v[56:59]
    v_mfma_f32_16x16x32_bf16 v[60:63], a[228:231], v[20:23], v[60:63]
    v_mfma_f32_16x16x32_bf16 v[64:67], a[228:231], v[24:27], v[64:67]
    v_mfma_f32_16x16x32_bf16 v[68:71], v[148:151], v[20:23], v[68:71]
    v_mfma_f32_16x16x32_bf16 v[72:75], v[148:151], v[24:27], v[72:75]
    v_mfma_f32_16x16x32_bf16 v[76:79], v[204:207], v[20:23], v[76:79]
    v_mfma_f32_16x16x32_bf16 v[80:83], v[204:207], v[24:27], v[80:83]
    ds_read_b128 v[20:23], v3 offset:6144
    ds_read_b128 v[24:27], v3 offset:7168
    s_waitcnt lgkmcnt(2)
    v_mfma_f32_16x16x32_bf16 v[28:31], a[8:11], v[12:15], v[28:31]
    v_mfma_f32_16x16x32_bf16 v[32:35], a[8:11], v[16:19], v[32:35]
    v_mfma_f32_16x16x32_bf16 v[36:39], a[64:67], v[12:15], v[36:39]
    v_mfma_f32_16x16x32_bf16 v[40:43], a[64:67], v[16:19], v[40:43]
    v_mfma_f32_16x16x32_bf16 v[44:47], a[120:123], v[12:15], v[44:47]
    v_mfma_f32_16x16x32_bf16 v[48:51], a[120:123], v[16:19], v[48:51]
    v_mfma_f32_16x16x32_bf16 v[52:55], a[176:179], v[12:15], v[52:55]
    v_mfma_f32_16x16x32_bf16 v[56:59], a[176:179], v[16:19], v[56:59]
    v_mfma_f32_16x16x32_bf16 v[60:63], a[232:235], v[12:15], v[60:63]
    v_mfma_f32_16x16x32_bf16 v[64:67], a[232:235], v[16:19], v[64:67]
    v_mfma_f32_16x16x32_bf16 v[68:71], v[152:155], v[12:15], v[68:71]
    v_mfma_f32_16x16x32_bf16 v[72:75], v[152:155], v[16:19], v[72:75]
    v_mfma_f32_16x16x32_bf16 v[76:79], v[208:211], v[12:15], v[76:79]
    v_mfma_f32_16x16x32_bf16 v[80:83], v[208:211], v[16:19], v[80:83]
    ds_read_b128 v[12:15], v3 offset:8192
    ds_read_b128 v[16:19], v3 offset:9216
    s_waitcnt lgkmcnt(2)
    v_mfma_f32_16x16x32_bf16 v[28:31], a[12:15], v[20:23], v[28:31]
    v_mfma_f32_16x16x32_bf16 v[32:35], a[12:15], v[24:27], v[32:35]
    v_mfma_f32_16x16x32_bf16 v[36:39], a[68:71], v[20:23], v[36:39]
    v_mfma_f32_16x16x32_bf16 v[40:43], a[68:71], v[24:27], v[40:43]
    v_mfma_f32_16x16x32_bf16 v[44:47], a[124:127], v[20:23], v[44:47]
    v_mfma_f32_16x16x32_bf16 v[48:51], a[124:127], v[24:27], v[48:51]
    v_mfma_f32_16x16x32_bf16 v[52:55], a[180:183], v[20:23], v[52:55]
    v_mfma_f32_16x16x32_bf16 v[56:59], a[180:183], v[24:27], v[56:59]
    v_mfma_f32_16x16x32_bf16 v[60:63], a[236:239], v[20:23], v[60:63]
    v_mfma_f32_16x16x32_bf16 v[64:67], a[236:239], v[24:27], v[64:67]
    v_mfma_f32_16x16x32_bf16 v[68:71], v[156:159], v[20:23], v[68:71]
    v_mfma_f32_16x16x32_bf16 v[72:75], v[156:159], v[24:27], v[72:75]
    v_mfma_f32_16x16x32_bf16 v[76:79], v[212:215], v[20:23], v[76:79]
    v_mfma_f32_16x16x32_bf16 v[80:83], v[212:215], v[24:27], v[80:83]
    ds_read_b128 v[20:23], v3 offset:10240
    ds_read_b128 v[24:27], v3 offset:11264
    s_waitcnt lgkmcnt(2)
    v_mfma_f32_16x16x32_bf16 v[28:31], a[16:19], v[12:15], v[28:31]
    v_mfma_f32_16x16x32_bf16 v[32:35], a[16:19], v[16:19], v[32:35]
    v_mfma_f32_16x16x32_bf16 v[36:39], a[72:75], v[12:15], v[36:39]
    v_mfma_f32_16x16x32_bf16 v[40:43], a[72:75], v[16:19], v[40:43]
    v_mfma_f32_16x16x32_bf16 v[44:47], a[128:131], v[12:15], v[44:47]
    v_mfma_f32_16x16x32_bf16 v[48:51], a[128:131], v[16:19], v[48:51]
    v_mfma_f32_16x16x32_bf16 v[52:55], a[184:187], v[12:15], v[52:55]
    v_mfma_f32_16x16x32_bf16 v[56:59], a[184:187], v[16:19], v[56:59]
    v_mfma_f32_16x16x32_bf16 v[60:63], a[240:243], v[12:15], v[60:63]
    v_mfma_f32_16x16x32_bf16 v[64:67], a[240:243], v[16:19], v[64:67]
    v_mfma_f32_16x16x32_bf16 v[68:71], v[160:163], v[12:15], v[68:71]
    v_mfma_f32_16x16x32_bf16 v[72:75], v[160:163], v[16:19], v[72:75]
    v_mfma_f32_16x16x32_bf16 v[76:79], v[216:219], v[12:15], v[76:79]
    v_mfma_f32_16x16x32_bf16 v[80:83], v[216:219], v[16:19], v[80:83]
    ds_read_b128 v[12:15], v3 offset:12288
    ds_read_b128 v[16:19], v3 offset:13312
    s_waitcnt lgkmcnt(2)
    v_mfma_f32_16x16x32_bf16 v[28:31], a[20:23], v[20:23], v[28:31]
    v_mfma_f32_16x16x32_bf16 v[32:35], a[20:23], v[24:27], v[32:35]
    v_mfma_f32_16x16x32_bf16 v[36:39], a[76:79], v[20:23], v[36:39]
    v_mfma_f32_16x16x32_bf16 v[40:43], a[76:79], v[24:27], v[40:43]
    v_mfma_f32_16x16x32_bf16 v[44:47], a[132:135], v[20:23], v[44:47]
    v_mfma_f32_16x16x32_bf16 v[48:51], a[132:135], v[24:27], v[48:51]
    v_mfma_f32_16x16x32_bf16 v[52:55], a[188:191], v[20:23], v[52:55]
    v_mfma_f32_16x16x32_bf16 v[56:59], a[188:191], v[24:27], v[56:59]
    v_mfma_f32_16x16x32_bf16 v[60:63], a[244:247], v[20:23], v[60:63]
    v_mfma_f32_16x16x32_bf16 v[64:67], a[244:247], v[24:27], v[64:67]
    v_mfma_f32_16x16x32_bf16 v[68:71], v[164:167], v[20:23], v[68:71]
    v_mfma_f32_16x16x32_bf16 v[72:75], v[164:167], v[24:27], v[72:75]
    v_mfma_f32_16x16x32_bf16 v[76:79], v[220:223], v[20:23], v[76:79]
    v_mfma_f32_16x16x32_bf16 v[80:83], v[220:223], v[24:27], v[80:83]
    ds_read_b128 v[20:23], v3 offset:14336
    ds_read_b128 v[24:27], v3 offset:15360
    s_waitcnt lgkmcnt(2)
    v_mfma_f32_16x16x32_bf16 v[28:31], a[24:27], v[12:15], v[28:31]
    v_mfma_f32_16x16x32_bf16 v[32:35], a[24:27], v[16:19], v[32:35]
    v_mfma_f32_16x16x32_bf16 v[36:39], a[80:83], v[12:15], v[36:39]
    v_mfma_f32_16x16x32_bf16 v[40:43], a[80:83], v[16:19], v[40:43]
    v_mfma_f32_16x16x32_bf16 v[44:47], a[136:139], v[12:15], v[44:47]
    v_mfma_f32_16x16x32_bf16 v[48:51], a[136:139], v[16:19], v[48:51]
    v_mfma_f32_16x16x32_bf16 v[52:55], a[192:195], v[12:15], v[52:55]
    v_mfma_f32_16x16x32_bf16 v[56:59], a[192:195], v[16:19], v[56:59]
    v_mfma_f32_16x16x32_bf16 v[60:63], a[248:251], v[12:15], v[60:63]
    v_mfma_f32_16x16x32_bf16 v[64:67], a[248:251], v[16:19], v[64:67]
    v_mfma_f32_16x16x32_bf16 v[68:71], v[168:171], v[12:15], v[68:71]
    v_mfma_f32_16x16x32_bf16 v[72:75], v[168:171], v[16:19], v[72:75]
    v_mfma_f32_16x16x32_bf16 v[76:79], v[224:227], v[12:15], v[76:79]
    v_mfma_f32_16x16x32_bf16 v[80:83], v[224:227], v[16:19], v[80:83]
    ds_read_b128 v[12:15], v3 offset:16384
    ds_read_b128 v[16:19], v3 offset:17408
    s_waitcnt lgkmcnt(2)
    v_mfma_f32_16x16x32_bf16 v[28:31], a[28:31], v[20:23], v[28:31]
    v_mfma_f32_16x16x32_bf16 v[32:35], a[28:31], v[24:27], v[32:35]
    v_mfma_f32_16x16x32_bf16 v[36:39], a[84:87], v[20:23], v[36:39]
    v_mfma_f32_16x16x32_bf16 v[40:43], a[84:87], v[24:27], v[40:43]
    v_mfma_f32_16x16x32_bf16 v[44:47], a[140:143], v[20:23], v[44:47]
    v_mfma_f32_16x16x32_bf16 v[48:51], a[140:143], v[24:27], v[48:51]
    v_mfma_f32_16x16x32_bf16 v[52:55], a[196:199], v[20:23], v[52:55]
    v_mfma_f32_16x16x32_bf16 v[56:59], a[196:199], v[24:27], v[56:59]
    v_mfma_f32_16x16x32_bf16 v[60:63], a[252:255], v[20:23], v[60:63]
    v_mfma_f32_16x16x32_bf16 v[64:67], a[252:255], v[24:27], v[64:67]
    v_mfma_f32_16x16x32_bf16 v[68:71], v[172:175], v[20:23], v[68:71]
    v_mfma_f32_16x16x32_bf16 v[72:75], v[172:175], v[24:27], v[72:75]
    v_mfma_f32_16x16x32_bf16 v[76:79], v[228:231], v[20:23], v[76:79]
    v_mfma_f32_16x16x32_bf16 v[80:83], v[228:231], v[24:27], v[80:83]
    ds_read_b128 v[20:23], v3 offset:18432
    ds_read_b128 v[24:27], v3 offset:19456
    s_waitcnt lgkmcnt(2)
    v_mfma_f32_16x16x32_bf16 v[28:31], a[32:35], v[12:15], v[28:31]
    v_mfma_f32_16x16x32_bf16 v[32:35], a[32:35], v[16:19], v[32:35]
    v_mfma_f32_16x16x32_bf16 v[36:39], a[88:91], v[12:15], v[36:39]
    v_mfma_f32_16x16x32_bf16 v[40:43], a[88:91], v[16:19], v[40:43]
    v_mfma_f32_16x16x32_bf16 v[44:47], a[144:147], v[12:15], v[44:47]
    v_mfma_f32_16x16x32_bf16 v[48:51], a[144:147], v[16:19], v[48:51]
    v_mfma_f32_16x16x32_bf16 v[52:55], a[200:203], v[12:15], v[52:55]
    v_mfma_f32_16x16x32_bf16 v[56:59], a[200:203], v[16:19], v[56:59]
    v_mfma_f32_16x16x32_bf16 v[60:63], v[120:123], v[12:15], v[60:63]
    v_mfma_f32_16x16x32_bf16 v[64:67], v[120:123], v[16:19], v[64:67]
    v_mfma_f32_16x16x32_bf16 v[68:71], v[176:179], v[12:15], v[68:71]
    v_mfma_f32_16x16x32_bf16 v[72:75], v[176:179], v[16:19], v[72:75]
    v_mfma_f32_16x16x32_bf16 v[76:79], v[232:235], v[12:15], v[76:79]
    v_mfma_f32_16x16x32_bf16 v[80:83], v[232:235], v[16:19], v[80:83]
    ds_read_b128 v[12:15], v3 offset:20480
    ds_read_b128 v[16:19], v3 offset:21504
    s_waitcnt lgkmcnt(2)
    v_mfma_f32_16x16x32_bf16 v[28:31], a[36:39], v[20:23], v[28:31]
    v_mfma_f32_16x16x32_bf16 v[32:35], a[36:39], v[24:27], v[32:35]
    v_mfma_f32_16x16x32_bf16 v[36:39], a[92:95], v[20:23], v[36:39]
    v_mfma_f32_16x16x32_bf16 v[40:43], a[92:95], v[24:27], v[40:43]
    v_mfma_f32_16x16x32_bf16 v[44:47], a[148:151], v[20:23], v[44:47]
    v_mfma_f32_16x16x32_bf16 v[48:51], a[148:151], v[24:27], v[48:51]
    v_mfma_f32_16x16x32_bf16 v[52:55], a[204:207], v[20:23], v[52:55]
    v_mfma_f32_16x16x32_bf16 v[56:59], a[204:207], v[24:27], v[56:59]
    v_mfma_f32_16x16x32_bf16 v[60:63], v[124:127], v[20:23], v[60:63]
    v_mfma_f32_16x16x32_bf16 v[64:67], v[124:127], v[24:27], v[64:67]
    v_mfma_f32_16x16x32_bf16 v[68:71], v[180:183], v[20:23], v[68:71]
    v_mfma_f32_16x16x32_bf16 v[72:75], v[180:183], v[24:27], v[72:75]
    v_mfma_f32_16x16x32_bf16 v[76:79], v[236:239], v[20:23], v[76:79]
    v_mfma_f32_16x16x32_bf16 v[80:83], v[236:239], v[24:27], v[80:83]
    ds_read_b128 v[20:23], v3 offset:22528
    ds_read_b128 v[24:27], v3 offset:23552
    s_waitcnt lgkmcnt(2)
    v_mfma_f32_16x16x32_bf16 v[28:31], a[40:43], v[12:15], v[28:31]
    v_mfma_f32_16x16x32_bf16 v[32:35], a[40:43], v[16:19], v[32:35]
    v_mfma_f32_16x16x32_bf16 v[36:39], a[96:99], v[12:15], v[36:39]
    v_mfma_f32_16x16x32_bf16 v[40:43], a[96:99], v[16:19], v[40:43]
    v_mfma_f32_16x16x32_bf16 v[44:47], a[152:155], v[12:15], v[44:47]
    v_mfma_f32_16x16x32_bf16 v[48:51], a[152:155], v[16:19], v[48:51]
    v_mfma_f32_16x16x32_bf16 v[52:55], a[208:211], v[12:15], v[52:55]
    v_mfma_f32_16x16x32_bf16 v[56:59], a[208:211], v[16:19], v[56:59]
    v_mfma_f32_16x16x32_bf16 v[60:63], v[128:131], v[12:15], v[60:63]
    v_mfma_f32_16x16x32_bf16 v[64:67], v[128:131], v[16:19], v[64:67]
    v_mfma_f32_16x16x32_bf16 v[68:71], v[184:187], v[12:15], v[68:71]
    v_mfma_f32_16x16x32_bf16 v[72:75], v[184:187], v[16:19], v[72:75]
    v_mfma_f32_16x16x32_bf16 v[76:79], v[240:243], v[12:15], v[76:79]
    v_mfma_f32_16x16x32_bf16 v[80:83], v[240:243], v[16:19], v[80:83]
    ds_read_b128 v[12:15], v3 offset:24576
    ds_read_b128 v[16:19], v3 offset:25600
    s_waitcnt lgkmcnt(2)
    v_mfma_f32_16x16x32_bf16 v[28:31], a[44:47], v[20:23], v[28:31]
    v_mfma_f32_16x16x32_bf16 v[32:35], a[44:47], v[24:27], v[32:35]
    v_mfma_f32_16x16x32_bf16 v[36:39], a[100:103], v[20:23], v[36:39]
    v_mfma_f32_16x16x32_bf16 v[40:43], a[100:103], v[24:27], v[40:43]
    v_mfma_f32_16x16x32_bf16 v[44:47], a[156:159], v[20:23], v[44:47]
    v_mfma_f32_16x16x32_bf16 v[48:51], a[156:159], v[24:27], v[48:51]
    v_mfma_f32_16x16x32_bf16 v[52:55], a[212:215], v[20:23], v[52:55]
    v_mfma_f32_16x16x32_bf16 v[56:59], a[212:215], v[24:27], v[56:59]
    v_mfma_f32_16x16x32_bf16 v[60:63], v[132:135], v[20:23], v[60:63]
    v_mfma_f32_16x16x32_bf16 v[64:67], v[132:135], v[24:27], v[64:67]
    v_mfma_f32_16x16x32_bf16 v[68:71], v[188:191], v[20:23], v[68:71]
    v_mfma_f32_16x16x32_bf16 v[72:75], v[188:191], v[24:27], v[72:75]
    v_mfma_f32_16x16x32_bf16 v[76:79], v[244:247], v[20:23], v[76:79]
    v_mfma_f32_16x16x32_bf16 v[80:83], v[244:247], v[24:27], v[80:83]
    ds_read_b128 v[20:23], v3 offset:26624
    ds_read_b128 v[24:27], v3 offset:27648
    s_waitcnt lgkmcnt(2)
    v_mfma_f32_16x16x32_bf16 v[28:31], a[48:51], v[12:15], v[28:31]
    v_mfma_f32_16x16x32_bf16 v[32:35], a[48:51], v[16:19], v[32:35]
    v_mfma_f32_16x16x32_bf16 v[36:39], a[104:107], v[12:15], v[36:39]
    v_mfma_f32_16x16x32_bf16 v[40:43], a[104:107], v[16:19], v[40:43]
    v_mfma_f32_16x16x32_bf16 v[44:47], a[160:163], v[12:15], v[44:47]
    v_mfma_f32_16x16x32_bf16 v[48:51], a[160:163], v[16:19], v[48:51]
    v_mfma_f32_16x16x32_bf16 v[52:55], a[216:219], v[12:15], v[52:55]
    v_mfma_f32_16x16x32_bf16 v[56:59], a[216:219], v[16:19], v[56:59]
    v_mfma_f32_16x16x32_bf16 v[60:63], v[136:139], v[12:15], v[60:63]
    v_mfma_f32_16x16x32_bf16 v[64:67], v[136:139], v[16:19], v[64:67]
    v_mfma_f32_16x16x32_bf16 v[68:71], v[192:195], v[12:15], v[68:71]
    v_mfma_f32_16x16x32_bf16 v[72:75], v[192:195], v[16:19], v[72:75]
    v_mfma_f32_16x16x32_bf16 v[76:79], v[248:251], v[12:15], v[76:79]
    v_mfma_f32_16x16x32_bf16 v[80:83], v[248:251], v[16:19], v[80:83]
    s_waitcnt lgkmcnt(0)
    v_mfma_f32_16x16x32_bf16 v[28:31], a[52:55], v[20:23], v[28:31]
    v_mfma_f32_16x16x32_bf16 v[32:35], a[52:55], v[24:27], v[32:35]
    v_mfma_f32_16x16x32_bf16 v[36:39], a[108:111], v[20:23], v[36:39]
    v_mfma_f32_16x16x32_bf16 v[40:43], a[108:111], v[24:27], v[40:43]
    v_mfma_f32_16x16x32_bf16 v[44:47], a[164:167], v[20:23], v[44:47]
    v_mfma_f32_16x16x32_bf16 v[48:51], a[164:167], v[24:27], v[48:51]
    v_mfma_f32_16x16x32_bf16 v[52:55], a[220:223], v[20:23], v[52:55]
    v_mfma_f32_16x16x32_bf16 v[56:59], a[220:223], v[24:27], v[56:59]
    v_mfma_f32_16x16x32_bf16 v[60:63], v[140:143], v[20:23], v[60:63]
    v_mfma_f32_16x16x32_bf16 v[64:67], v[140:143], v[24:27], v[64:67]
    v_mfma_f32_16x16x32_bf16 v[68:71], v[196:199], v[20:23], v[68:71]
    v_mfma_f32_16x16x32_bf16 v[72:75], v[196:199], v[24:27], v[72:75]
    v_mfma_f32_16x16x32_bf16 v[76:79], v[252:255], v[20:23], v[76:79]
    v_mfma_f32_16x16x32_bf16 v[80:83], v[252:255], v[24:27], v[80:83]
    s_nop 7
    v_cvt_pk_bf16_f32 v84, v28, v29
    v_cvt_pk_bf16_f32 v85, v30, v31
    v_cvt_pk_bf16_f32 v86, v36, v37
    v_cvt_pk_bf16_f32 v87, v38, v39
    v_cvt_pk_bf16_f32 v88, v32, v33
    v_cvt_pk_bf16_f32 v89, v34, v35
    v_cvt_pk_bf16_f32 v90, v40, v41
    v_cvt_pk_bf16_f32 v91, v42, v43
    v_cvt_pk_bf16_f32 v92, v44, v45
    v_cvt_pk_bf16_f32 v93, v46, v47
    v_cvt_pk_bf16_f32 v94, v52, v53
    v_cvt_pk_bf16_f32 v95, v54, v55
    v_cvt_pk_bf16_f32 v96, v48, v49
    v_cvt_pk_bf16_f32 v97, v50, v51
    v_cvt_pk_bf16_f32 v98, v56, v57
    v_cvt_pk_bf16_f32 v99, v58, v59
    v_cvt_pk_bf16_f32 v100, v60, v61
    v_cvt_pk_bf16_f32 v101, v62, v63
    v_cvt_pk_bf16_f32 v102, v68, v69
    v_cvt_pk_bf16_f32 v103, v70, v71
    v_cvt_pk_bf16_f32 v104, v64, v65
    v_cvt_pk_bf16_f32 v105, v66, v67
    v_cvt_pk_bf16_f32 v106, v72, v73
    v_cvt_pk_bf16_f32 v107, v74, v75
    v_cvt_pk_bf16_f32 v108, v76, v77
    v_cvt_pk_bf16_f32 v109, v78, v79
    v_mov_b32 v110, 0
    v_mov_b32 v111, 0
    v_cvt_pk_bf16_f32 v112, v80, v81
    v_cvt_pk_bf16_f32 v113, v82, v83
    v_mov_b32 v114, 0
    v_mov_b32 v115, 0
    v_add_u32 v11, 0, v8
    v_lshrrev_b32 v1, 2, v11
    v_lshlrev_b32 v1, 11, v1
    v_and_b32 v116, 3, v11
    v_lshl_add_u32 v116, v116, 8, v1
    v_add_u32 v116, v116, v9
    ds_read_b64 v[52:53], v116 offset:0
    ds_read_b64 v[56:57], v116 offset:1024
    v_add_u32 v11, 2, v8
    v_lshrrev_b32 v1, 2, v11
    v_lshlrev_b32 v1, 11, v1
    v_and_b32 v116, 3, v11
    v_lshl_add_u32 v116, v116, 8, v1
    v_add_u32 v116, v116, v9
    ds_read_b64 v[54:55], v116 offset:0
    ds_read_b64 v[58:59], v116 offset:1024
    v_add_u32 v11, 4, v8
    v_lshrrev_b32 v1, 2, v11
    v_lshlrev_b32 v1, 11, v1
    v_and_b32 v116, 3, v11
    v_lshl_add_u32 v116, v116, 8, v1
    v_add_u32 v116, v116, v9
    ds_read_b64 v[60:61], v116 offset:0
    ds_read_b64 v[64:65], v116 offset:1024
    v_add_u32 v11, 6, v8
    v_lshrrev_b32 v1, 2, v11
    v_lshlrev_b32 v1, 11, v1
    v_and_b32 v116, 3, v11
    v_lshl_add_u32 v116, v116, 8, v1
    v_add_u32 v116, v116, v9
    ds_read_b64 v[62:63], v116 offset:0
    ds_read_b64 v[66:67], v116 offset:1024
    v_add_u32 v11, 8, v8
    v_lshrrev_b32 v1, 2, v11
    v_lshlrev_b32 v1, 11, v1
    v_and_b32 v116, 3, v11
    v_lshl_add_u32 v116, v116, 8, v1
    v_add_u32 v116, v116, v9
    ds_read_b64 v[68:69], v116 offset:0
    ds_read_b64 v[72:73], v116 offset:1024
    v_add_u32 v11, 10, v8
    v_lshrrev_b32 v1, 2, v11
    v_lshlrev_b32 v1, 11, v1
    v_and_b32 v116, 3, v11
    v_lshl_add_u32 v116, v116, 8, v1
    v_add_u32 v116, v116, v9
    ds_read_b64 v[70:71], v116 offset:0
    ds_read_b64 v[74:75], v116 offset:1024
    v_add_u32 v11, 12, v8
    v_lshrrev_b32 v1, 2, v11
    v_lshlrev_b32 v1, 11, v1
    v_and_b32 v116, 3, v11
    v_lshl_add_u32 v116, v116, 8, v1
    v_add_u32 v116, v116, v9
    ds_read_b64 v[76:77], v116 offset:0
    ds_read_b64 v[80:81], v116 offset:1024
    v_mov_b32 v78, 0
    v_mov_b32 v79, 0
    v_mov_b32 v82, 0
    v_mov_b32 v83, 0
    s_waitcnt lgkmcnt(0)
    v_mfma_f32_16x16x32_bf16 v[28:31], v[52:55], v[84:87], 0
    v_mfma_f32_16x16x32_bf16 v[32:35], v[52:55], v[88:91], 0
    v_mfma_f32_16x16x32_bf16 v[36:39], v[56:59], v[84:87], 0
    v_mfma_f32_16x16x32_bf16 v[40:43], v[56:59], v[88:91], 0
    v_mfma_f32_16x16x32_bf16 v[28:31], v[60:63], v[92:95], v[28:31]
    v_mfma_f32_16x16x32_bf16 v[32:35], v[60:63], v[96:99], v[32:35]
    v_mfma_f32_16x16x32_bf16 v[36:39], v[64:67], v[92:95], v[36:39]
    v_mfma_f32_16x16x32_bf16 v[40:43], v[64:67], v[96:99], v[40:43]
    v_mfma_f32_16x16x32_bf16 v[28:31], v[68:71], v[100:103], v[28:31]
    v_mfma_f32_16x16x32_bf16 v[32:35], v[68:71], v[104:107], v[32:35]
    v_mfma_f32_16x16x32_bf16 v[36:39], v[72:75], v[100:103], v[36:39]
    v_mfma_f32_16x16x32_bf16 v[40:43], v[72:75], v[104:107], v[40:43]
    v_mfma_f32_16x16x32_bf16 v[28:31], v[76:79], v[108:111], v[28:31]
    v_mfma_f32_16x16x32_bf16 v[32:35], v[76:79], v[112:115], v[32:35]
    v_mfma_f32_16x16x32_bf16 v[36:39], v[80:83], v[108:111], v[36:39]
    v_mfma_f32_16x16x32_bf16 v[40:43], v[80:83], v[112:115], v[40:43]
    s_lshl_b32 s28, s22, 7
    s_add_u32 s28, s28, 32538624
    s_cmp_eq_u32 s22, 63
    s_cselect_b32 s28, 32548864, s28
    s_mov_b32 s34, 0
WF_31:
    buffer_load_dword v11, v6, s[8:11], s28 offen sc1
    s_add_u32 s34, s34, 1
    s_cmp_gt_u32 s34, 4194304
    s_cbranch_scc1 TK_ABORT
    s_waitcnt vmcnt(0)
    v_cmp_gt_u32 vcc, 14, v11
    s_cbranch_vccnz WF_31
    s_mul_i32 s27, s22, 7168
    s_add_u32 s27, s27, 30932992
    v_add_u32 v11, 0, v8
    v_lshl_add_u32 v116, v11, 7, v10
    buffer_load_dwordx2 v[52:53], v116, s[8:11], s27 offen sc1
    v_add_u32 v11, 2, v8
    v_lshl_add_u32 v116, v11, 7, v10
    buffer_load_dwordx2 v[54:55], v116, s[8:11], s27 offen sc1
    v_add_u32 v11, 4, v8
    v_lshl_add_u32 v116, v11, 7, v10
    buffer_load_dwordx2 v[56:57], v116, s[8:11], s27 offen sc1
    v_add_u32 v11, 6, v8
    v_lshl_add_u32 v116, v11, 7, v10
    buffer_load_dwordx2 v[58:59], v116, s[8:11], s27 offen sc1
    v_add_u32 v11, 8, v8
    v_lshl_add_u32 v116, v11, 7, v10
    buffer_load_dwordx2 v[60:61], v116, s[8:11], s27 offen sc1
    v_add_u32 v11, 10, v8
    v_lshl_add_u32 v116, v11, 7, v10
    buffer_load_dwordx2 v[62:63], v116, s[8:11], s27 offen sc1
    v_add_u32 v11, 12, v8
    v_lshl_add_u32 v116, v11, 7, v10
    buffer_load_dwordx2 v[64:65], v116, s[8:11], s27 offen sc1
    v_mov_b32 v66, 0
    v_mov_b32 v67, 0
    s_waitcnt vmcnt(0)
    v_mfma_f32_16x16x32_bf16 v[44:47], v[52:55], v[84:87], 0
    v_mfma_f32_16x16x32_bf16 v[48:51], v[52:55], v[88:91], 0
    v_mfma_f32_16x16x32_bf16 v[44:47], v[56:59], v[92:95], v[44:47]
    v_mfma_f32_16x16x32_bf16 v[48:51], v[56:59], v[96:99], v[48:51]
    v_mfma_f32_16x16x32_bf16 v[44:47], v[60:63], v[100:103], v[44:47]
    v_mfma_f32_16x16x32_bf16 v[48:51], v[60:63], v[104:107], v[48:51]
    v_mfma_f32_16x16x32_bf16 v[44:47], v[64:67], v[108:111], v[44:47]
    v_mfma_f32_16x16x32_bf16 v[48:51], v[64:67], v[112:115], v[48:51]
    s_mul_i32 s28, s20, 6656
    s_add_u32 s28, s28, 36864
    v_mul_u32_u24 v11, 208, v4
    v_lshl_add_u32 v11, v5, 4, v11
    v_add_u32 v11, s28, v11
    s_nop 4
    ds_write_b128 v11, v[28:31] offset:0
    ds_write_b128 v11, v[32:35] offset:3328
    ds_write_b128 v11, v[36:39] offset:64
    ds_write_b128 v11, v[40:43] offset:3392
    ds_write_b128 v11, v[44:47] offset:128
    ds_write_b128 v11, v[48:51] offset:3456
    s_waitcnt lgkmcnt(0)
    s_barrier
    s_add_u32 s31, s22, s23
    s_cmp_lt_u32 s31, 64
    s_cbranch_scc0 W2_NOPF
    s_mul_i32 s27, s31, 28672
    s_add_u32 s27, s27, s26
    s_mov_b32 m0, s26
    s_nop 0
    buffer_load_dwordx4 v3, s[8:11], s27 offen offset:0  lds
    buffer_load_dwordx4 v3, s[8:11], s27 offen offset:1024  lds
    buffer_load_dwordx4 v3, s[8:11], s27 offen offset:2048  lds
    buffer_load_dwordx4 v3, s[8:11], s27 offen offset:3072  lds
    s_add_u32 s28, s26, 4096
    s_add_u32 s29, s27, 4096
    s_mov_b32 m0, s28
    s_nop 0
    buffer_load_dwordx4 v3, s[8:11], s29 offen offset:0  lds
    buffer_load_dwordx4 v3, s[8:11], s29 offen offset:1024  lds
    buffer_load_dwordx4 v3, s[8:11], s29 offen offset:2048  lds
W2_NOPF:
    v_lshrrev_b32 v12, 3, v0
    v_and_b32 v13, 7, v0
    v_mul_u32_u24 v14, 208, v12
    v_add_u32 v14, 36864, v14
    v_lshl_add_u32 v15, v13, 4, v14
    v_lshl_add_u32 v14, v13, 2, v14
    ds_read_b128 v[20:23], v15 offset:0
    ds_read_b32 v36, v14 offset:128
    ds_read_b128 v[24:27], v15 offset:6656
    ds_read_b32 v37, v14 offset:6784
    ds_read_b128 v[28:31], v15 offset:13312
    ds_read_b32 v38, v14 offset:13440
    ds_read_b128 v[32:35], v15 offset:19968
    ds_read_b32 v39, v14 offset:20096
    s_waitcnt lgkmcnt(0)
    v_add_f32 v20, v20, v24
    v_add_f32 v28, v28, v32
    v_add_f32 v20, v20, v28
    v_add_f32 v21, v21, v25
    v_add_f32 v29, v29, v33
    v_add_f32 v21, v21, v29
    v_add_f32 v22, v22, v26
    v_add_f32 v30, v30, v34
    v_add_f32 v22, v22, v30
    v_add_f32 v23, v23, v27
    v_add_f32 v31, v31, v35
    v_add_f32 v23, v23, v31
    v_add_f32 v36, v36, v37
    v_add_f32 v38, v38, v39
    v_add_f32 v24, v36, v38
    v_lshlrev_b32 v16, 2, v13
    v_mov_b32 v17, 0xff800000
    v_add_u32 v18, 0, v16
    v_cmp_le_u32 vcc, v18, v12
    s_nop 1
    v_cndmask_b32 v20, v17, v20, vcc
    v_add_u32 v18, 1, v16
    v_cmp_le_u32 vcc, v18, v12
    s_nop 1
    v_cndmask_b32 v21, v17, v21, vcc
    v_add_u32 v18, 2, v16
    v_cmp_le_u32 vcc, v18, v12
    s_nop 1
    v_cndmask_b32 v22, v17, v22, vcc
    v_add_u32 v18, 3, v16
    v_cmp_le_u32 vcc, v18, v12
    s_nop 1
    v_cndmask_b32 v23, v17, v23, vcc
    v_max3_f32 v26, v20, v21, v22
    v_max3_f32 v26, v26, v23, v24
    s_nop 1
    v_max_f32_dpp v26, v26, v26 quad_perm:[1,0,3,2] row_mask:0xf bank_mask:0xf
    s_nop 1
    v_max_f32_dpp v26, v26, v26 quad_perm:[2,3,0,1] row_mask:0xf bank_mask:0xf
    s_nop 1
    v_max_f32_dpp v26, v26, v26 row_half_mirror row_mask:0xf bank_mask:0xf
    s_nop 1
    v_sub_f32 v20, v20, v26
    v_sub_f32 v21, v21, v26
    v_sub_f32 v22, v22, v26
    v_sub_f32 v23, v23, v26
    v_sub_f32 v24, v24, v26
    v_exp_f32 v20, v20
    v_exp_f32 v21, v21
    v_exp_f32 v22, v22
    v_exp_f32 v23, v23
    v_exp_f32 v24, v24
    s_nop 0
    v_add_f32 v26, v20, v21
    v_add_f32 v27, v22, v23
    v_add_f32 v26, v26, v27
    v_add_f32 v26, v26, v24
    s_nop 1
    v_add_f32_dpp v26, v26, v26 quad_perm:[1,0,3,2] row_mask:0xf bank_mask:0xf
    s_nop 1
    v_add_f32_dpp v26, v26, v26 quad_perm:[2,3,0,1] row_mask:0xf bank_mask:0xf
    s_nop 1
    v_add_f32_dpp v26, v26, v26 row_half_mirror row_mask:0xf bank_mask:0xf
    s_nop 1
    v_rcp_f32 v26, v26
    s_nop 0
    v_mul_f32 v20, v20, v26
    v_mul_f32 v21, v21, v26
    v_mul_f32 v22, v22, v26
    v_mul_f32 v23, v23, v26
    v_mul_f32 v24, v24, v26
    v_cvt_pk_bf16_f32 v28, v20, v21
    v_cvt_pk_bf16_f32 v29, v22, v23
    v_cvt_pk_bf16_f32 v30, v24, v24
    v_lshrrev_b32 v16, 4, v12
    v_lshlrev_b32 v16, 10, v16
    v_and_b32 v17, 15, v12
    v_lshl_add_u32 v16, v17, 4, v16
    v_lshrrev_b32 v17, 1, v13
    v_lshl_add_u32 v18, v17, 8, v16
    v_and_b32 v17, 1, v13
    v_lshl_add_u32 v18, v17, 3, v18
    s_mul_i32 s28, s22, 40960
    s_add_u32 s28, s28, 71303168
    s_lshl_b32 s29, s21, 11
    s_add_u32 s29, s29, s28
    buffer_store_dwordx2 v[28:29], v18, s[8:11], s29 offen sc1
    s_lshr_b32 s29, s21, 2
    s_lshl_b32 s29, s29, 11
    s_and_b32 s27, s21, 3
    s_lshl_b32 s27, s27, 8
    s_add_u32 s29, s29, s27
    s_add_u32 s29, s29, s28
    s_add_u32 s29, s29, 32768
    v_lshl_add_u32 v18, v13, 1, v16
    buffer_store_short v30, v18, s[8:11], s29 offen sc1
    s_waitcnt vmcnt(0)
    s_barrier
    s_lshl_b32 s28, s22, 7
    s_add_u32 s28, s28, 32514048
    s_cmp_eq_u32 s20, 0
    s_cbranch_scc0 SF_32
    s_mov_b64 exec, 1
    buffer_atomic_add v7, v6, s[8:11], s28 offen
    s_mov_b64 exec, -1
SF_32:
    s_add_u32 s22, s22, s23
    s_cmp_lt_u32 s22, 64
    s_cbranch_scc1 W2_LOOP
    s_endpgm
ROLE_W3:
    s_load_dwordx2 s[16:17], s[0:1], 0
    v_and_b32 v4, 15, v2
    v_lshrrev_b32 v5, 4, v2
    v_mov_b32 v6, 0
    v_mov_b32 v7, 1
    s_lshl_b32 s24, s21, 2
    s_add_u32 s24, s24, s20
    v_mul_u32_u24 v8, 7168, v5
    v_lshl_add_u32 v8, v4, 4, v8
    v_mul_u32_u24 v9, 896, v4
    v_lshl_add_u32 v9, v5, 3, v9
    s_lshl_b32 s25, s24, 5
    v_add_u32 v9, s25, v9
    s_waitcnt lgkmcnt(0)
    s_mov_b32 s12, s16
    s_mov_b32 s13, s17
    s_mov_b32 s14, 1835008
    s_mov_b32 s15, 0x00020000
W3_LOOP:
    s_lshl_b32 s33, s22, 7
    s_add_u32 s29, s33, 32505856
    s_mov_b32 s34, 0
WF_33:
    buffer_load_dword v11, v6, s[8:11], s29 offen sc1
    s_add_u32 s34, s34, 1
    s_cmp_gt_u32 s34, 4194304
    s_cbranch_scc1 TK_ABORT
    s_waitcnt vmcnt(0)
    v_cmp_gt_u32 vcc, 16, v11
    s_cbranch_vccnz WF_33
    s_mul_i32 s28, s22, 458752
    s_lshl_b32 s29, s24, 8
    s_add_u32 s28, s28, s29
    s_add_u32 s30, s28, 33554432
    s_add_u32 s31, s30, 0
    buffer_load_dwordx4 v[32:35], v8, s[8:11], s31 offen sc1
    s_add_u32 s31, s30, 28672
    buffer_load_dwordx4 v[36:39], v8, s[8:11], s31 offen sc1
    s_add_u32 s31, s30, 57344
    buffer_load_dwordx4 v[40:43], v8, s[8:11], s31 offen sc1
    s_add_u32 s31, s30, 86016
    buffer_load_dwordx4 v[44:47], v8, s[8:11], s31 offen sc1
    s_add_u32 s31, s30, 114688
    buffer_load_dwordx4 v[48:51], v8, s[8:11], s31 offen sc1
    s_add_u32 s31, s30, 143360
    buffer_load_dwordx4 v[52:55], v8, s[8:11], s31 offen sc1
    s_add_u32 s31, s30, 172032
    buffer_load_dwordx4 v[56:59], v8, s[8:11], s31 offen sc1
    s_add_u32 s31, s30, 200704
    buffer_load_dwordx4 v[60:63], v8, s[8:11], s31 offen sc1
    s_add_u32 s31, s30, 229376
    buffer_load_dwordx4 v[64:67], v8, s[8:11], s31 offen sc1
    s_add_u32 s31, s30, 258048
    buffer_load_dwordx4 v[68:71], v8, s[8:11], s31 offen sc1
    s_add_u32 s31, s30, 286720
    buffer_load_dwordx4 v[72:75], v8, s[8:11], s31 offen sc1
    s_add_u32 s31, s30, 315392
    buffer_load_dwordx4 v[76:79], v8, s[8:11], s31 offen sc1
    s_add_u32 s31, s30, 344064
    buffer_load_dwordx4 v[80:83], v8, s[8:11], s31 offen sc1
    s_add_u32 s31, s30, 372736
    buffer_load_dwordx4 v[84:87], v8, s[8:11], s31 offen sc1
    s_add_u32 s31, s30, 401408
    buffer_load_dwordx4 v[88:91], v8, s[8:11], s31 offen sc1
    s_add_u32 s31, s30, 430080
    buffer_load_dwordx4 v[92:95], v8, s[8:11], s31 offen sc1
    s_mul_i32 s28, s22, 28672
    s_add_u32 s31, s28, 0
    buffer_load_dwordx2 v[112:113], v9, s[12:15], s31 offen
    s_add_u32 s31, s28, 14336
    buffer_load_dwordx2 v[114:115], v9, s[12:15], s31 offen
    s_add_u32 s29, s33, 32514048
    s_mov_b32 s34, 0
WF_34:
    buffer_load_dword v11, v6, s[8:11], s29 offen sc1
    s_add_u32 s34, s34, 1
    s_cmp_gt_u32 s34, 4194304
    s_cbranch_scc1 TK_ABORT
    s_waitcnt vmcnt(0)
    v_cmp_gt_u32 vcc, 16, v11
    s_cbranch_vccnz WF_34
    s_mul_i32 s28, s22, 40960
    s_add_u32 s28, s28, 71303168
    s_mul_i32 s29, s20, 10240
    s_add_u32 s28, s28, s29
    s_add_u32 s30, s29, 0
    s_add_u32 s31, s28, 0
    s_mov_b32 m0, s30
    s_nop 0
    buffer_load_dwordx4 v3, s[8:11], s31 offen offset:0 sc1 lds
    buffer_load_dwordx4 v3, s[8:11], s31 offen offset:1024 sc1 lds
    buffer_load_dwordx4 v3, s[8:11], s31 offen offset:2048 sc1 lds
    buffer_load_dwordx4 v3, s[8:11], s31 offen offset:3072 sc1 lds
    s_add_u32 s30, s29, 4096
    s_add_u32 s31, s28, 4096
    s_mov_b32 m0, s30
    s_nop 0
    buffer_load_dwordx4 v3, s[8:11], s31 offen offset:0 sc1 lds
    buffer_load_dwordx4 v3, s[8:11], s31 offen offset:1024 sc1 lds
    buffer_load_dwordx4 v3, s[8:11], s31 offen offset:2048 sc1 lds
    buffer_load_dwordx4 v3, s[8:11], s31 offen offset:3072 sc1 lds
    s_add_u32 s30, s29, 8192
    s_add_u32 s31, s28, 8192
    s_mov_b32 m0, s30
    s_nop 0
    buffer_load_dwordx4 v3, s[8:11], s31 offen offset:0 sc1 lds
    buffer_load_dwordx4 v3, s[8:11], s31 offen offset:1024 sc1 lds
    s_add_u32 s29, s33, 32538752
    s_mov_b32 s34, 0
WF_35:
    buffer_load_dword v11, v6, s[8:11], s29 offen sc1
    s_add_u32 s34, s34, 1
    s_cmp_gt_u32 s34, 4194304
    s_cbranch_scc1 TK_ABORT
    s_waitcnt vmcnt(0)
    v_cmp_gt_u32 vcc, 14, v11
    s_cbranch_vccnz WF_35
    s_mul_i32 s28, s22, 114688
    s_lshl_b32 s29, s24, 8
    s_add_u32 s28, s28, s29
    s_add_u32 s30, s28, 62914560
    s_add_u32 s31, s30, 0
    buffer_load_dwordx4 v[96:99], v8, s[8:11], s31 offen sc1
    s_add_u32 s31, s30, 28672
    buffer_load_dwordx4 v[100:103], v8, s[8:11], s31 offen sc1
    s_add_u32 s31, s30, 57344
    buffer_load_dwordx4 v[104:107], v8, s[8:11], s31 offen sc1
    s_add_u32 s31, s30, 86016
    buffer_load_dwordx4 v[108:111], v8, s[8:11], s31 offen sc1
    s_mul_i32 s28, s22, 28672
    s_waitcnt vmcnt(0)
    s_barrier
    ds_read_b128 v[12:15], v3 offset:0
    ds_read_b128 v[16:19], v3 offset:1024
    ds_read_b128 v[120:123], v3 offset:2048
    ds_read_b128 v[124:127], v3 offset:3072
    s_waitcnt lgkmcnt(2)
    v_mfma_f32_16x16x32_bf16 v[24:27], v[32:35], v[12:15], 0
    v_mfma_f32_16x16x32_bf16 v[28:31], v[32:35], v[16:19], 0
    ds_read_b128 v[12:15], v3 offset:4096
    ds_read_b128 v[16:19], v3 offset:5120
    s_waitcnt lgkmcnt(2)
    v_mfma_f32_16x16x32_bf16 v[24:27], v[36:39], v[120:123], v[24:27]
    v_mfma_f32_16x16x32_bf16 v[28:31], v[36:39], v[124:127], v[28:31]
    ds_read_b128 v[120:123], v3 offset:6144
    ds_read_b128 v[124:127], v3 offset:7168
    s_waitcnt lgkmcnt(2)
    v_mfma_f32_16x16x32_bf16 v[24:27], v[40:43], v[12:15], v[24:27]
    v_mfma_f32_16x16x32_bf16 v[28:31], v[40:43], v[16:19], v[28:31]
    ds_read_b128 v[12:15], v3 offset:8192
    ds_read_b128 v[16:19], v3 offset:9216
    s_waitcnt lgkmcnt(2)
    v_mfma_f32_16x16x32_bf16 v[24:27], v[44:47], v[120:123], v[24:27]
    v_mfma_f32_16x16x32_bf16 v[28:31], v[44:47], v[124:127], v[28:31]
    ds_read_b128 v[120:123], v3 offset:10240
    ds_read_b128 v[124:127], v3 offset:11264
    s_waitcnt lgkmcnt(2)
    v_mfma_f32_16x16x32_bf16 v[24:27], v[48:51], v[12:15], v[24:27]
    v_mfma_f32_16x16x32_bf16 v[28:31], v[48:51], v[16:19], v[28:31]
    ds_read_b128 v[12:15], v3 offset:12288
    ds_read_b128 v[16:19], v3 offset:13312
    s_waitcnt lgkmcnt(2)
    v_mfma_f32_16x16x32_bf16 v[24:27], v[52:55], v[120:123], v[24:27]
    v_mfma_f32_16x16x32_bf16 v[28:31], v[52:55], v[124:127], v[28:31]
    ds_read_b128 v[120:123], v3 offset:14336
    ds_read_b128 v[124:127], v3 offset:15360
    s_waitcnt lgkmcnt(2)
    v_mfma_f32_16x16x32_bf16 v[24:27], v[56:59], v[12:15], v[24:27]
    v_mfma_f32_16x16x32_bf16 v[28:31], v[56:59], v[16:19], v[28:31]
    ds_read_b128 v[12:15], v3 offset:16384
    ds_read_b128 v[16:19], v3 offset:17408
    s_waitcnt lgkmcnt(2)
    v_mfma_f32_16x16x32_bf16 v[24:27], v[60:63], v[120:123], v[24:27]
    v_mfma_f32_16x16x32_bf16 v[28:31], v[60:63], v[124:127], v[28:31]
    ds_read_b128 v[120:123], v3 offset:18432
    ds_read_b128 v[124:127], v3 offset:19456
    s_waitcnt lgkmcnt(2)
    v_mfma_f32_16x16x32_bf16 v[24:27], v[64:67], v[12:15], v[24:27]
    v_mfma_f32_16x16x32_bf16 v[28:31], v[64:67], v[16:19], v[28:31]
    ds_read_b128 v[12:15], v3 offset:20480
    ds_read_b128 v[16:19], v3 offset:21504
    s_waitcnt lgkmcnt(2)
    v_mfma_f32_16x16x32_bf16 v[24:27], v[68:71], v[120:123], v[24:27]
    v_mfma_f32_16x16x32_bf16 v[28:31], v[68:71], v[124:127], v[28:31]
    ds_read_b128 v[120:123], v3 offset:22528
    ds_read_b128 v[124:127], v3 offset:23552
    s_waitcnt lgkmcnt(2)
    v_mfma_f32_16x16x32_bf16 v[24:27], v[72:75], v[12:15], v[24:27]
    v_mfma_f32_16x16x32_bf16 v[28:31], v[72:75], v[16:19], v[28:31]
    ds_read_b128 v[12:15], v3 offset:24576
    ds_read_b128 v[16:19], v3 offset:25600
    s_waitcnt lgkmcnt(2)
    v_mfma_f32_16x16x32_bf16 v[24:27], v[76:79], v[120:123], v[24:27]
    v_mfma_f32_16x16x32_bf16 v[28:31], v[76:79], v[124:127], v[28:31]
    ds_read_b128 v[120:123], v3 offset:26624
    ds_read_b128 v[124:127], v3 offset:27648
    s_waitcnt lgkmcnt(2)
    v_mfma_f32_16x16x32_bf16 v[24:27], v[80:83], v[12:15], v[24:27]
    v_mfma_f32_16x16x32_bf16 v[28:31], v[80:83], v[16:19], v[28:31]
    ds_read_b128 v[12:15], v3 offset:28672
    ds_read_b128 v[16:19], v3 offset:29696
    s_waitcnt lgkmcnt(2)
    v_mfma_f32_16x16x32_bf16 v[24:27], v[84:87], v[120:123], v[24:27]
    v_mfma_f32_16x16x32_bf16 v[28:31], v[84:87], v[124:127], v[28:31]
    ds_read_b128 v[120:123], v3 offset:30720
    ds_read_b128 v[124:127], v3 offset:31744
    s_waitcnt lgkmcnt(2)
    v_mfma_f32_16x16x32_bf16 v[24:27], v[88:91], v[12:15], v[24:27]
    v_mfma_f32_16x16x32_bf16 v[28:31], v[88:91], v[16:19], v[28:31]
    ds_read_b128 v[12:15], v3 offset:32768
    ds_read_b128 v[16:19], v3 offset:33792
    s_waitcnt lgkmcnt(2)
    v_mfma_f32_16x16x32_bf16 v[24:27], v[92:95], v[120:123], v[24:27]
    v_mfma_f32_16x16x32_bf16 v[28:31], v[92:95], v[124:127], v[28:31]
    ds_read_b128 v[120:123], v3 offset:34816
    ds_read_b128 v[124:127], v3 offset:35840
    s_waitcnt lgkmcnt(2)
    v_mfma_f32_16x16x32_bf16 v[24:27], v[96:99], v[12:15], v[24:27]
    v_mfma_f32_16x16x32_bf16 v[28:31], v[96:99], v[16:19], v[28:31]
    ds_read_b128 v[12:15], v3 offset:36864
    ds_read_b128 v[16:19], v3 offset:37888
    s_waitcnt lgkmcnt(2)
    v_mfma_f32_16x16x32_bf16 v[24:27], v[100:103], v[120:123], v[24:27]
    v_mfma_f32_16x16x32_bf16 v[28:31], v[100:103], v[124:127], v[28:31]
    ds_read_b128 v[120:123], v3 offset:38912
    ds_read_b128 v[124:127], v3 offset:39936
    s_waitcnt lgkmcnt(2)
    v_mfma_f32_16x16x32_bf16 v[24:27], v[104:107], v[12:15], v[24:27]
    v_mfma_f32_16x16x32_bf16 v[28:31], v[104:107], v[16:19], v[28:31]
    s_waitcnt lgkmcnt(0)
    v_mfma_f32_16x16x32_bf16 v[24:27], v[108:111], v[120:123], v[24:27]
    v_mfma_f32_16x16x32_bf16 v[28:31], v[108:111], v[124:127], v[28:31]
    s_nop 7
    s_nop 1
    v_cvt_pk_bf16_f32 v16, v24, v25
    v_cvt_pk_bf16_f32 v17, v26, v27
    v_lshlrev_b32 v18, 16, v16
    v_and_b32 v19, 0xffff0000, v16
    v_lshlrev_b32 v20, 16, v112
    v_and_b32 v21, 0xffff0000, v112
    v_add_f32 v18, v18, v20
    v_add_f32 v19, v19, v21
    v_cvt_pk_bf16_f32 v22, v18, v19
    v_lshlrev_b32 v18, 16, v17
    v_and_b32 v19, 0xffff0000, v17
    v_lshlrev_b32 v20, 16, v113
    v_and_b32 v21, 0xffff0000, v113
    v_add_f32 v18, v18, v20
    v_add_f32 v19, v19, v21
    v_cvt_pk_bf16_f32 v23, v18, v19
    s_add_u32 s31, s28, 75497472
    buffer_store_dwordx2 v[22:23], v9, s[8:11], s31 offen sc1
    s_nop 1
    v_cvt_pk_bf16_f32 v16, v28, v29
    v_cvt_pk_bf16_f32 v17, v30, v31
    v_lshlrev_b32 v18, 16, v16
    v_and_b32 v19, 0xffff0000, v16
    v_lshlrev_b32 v20, 16, v114
    v_and_b32 v21, 0xffff0000, v114
    v_add_f32 v18, v18, v20
    v_add_f32 v19, v19, v21
    v_cvt_pk_bf16_f32 v22, v18, v19
    v_lshlrev_b32 v18, 16, v17
    v_and_b32 v19, 0xffff0000, v17
    v_lshlrev_b32 v20, 16, v115
    v_and_b32 v21, 0xffff0000, v115
    v_add_f32 v18, v18, v20
    v_add_f32 v19, v19, v21
    v_cvt_pk_bf16_f32 v23, v18, v19
    s_add_u32 s31, s28, 75511808
    buffer_store_dwordx2 v[22:23], v9, s[8:11], s31 offen sc1
    s_nop 1
    s_waitcnt vmcnt(0)
    s_barrier
    s_lshl_b32 s28, s22, 7
    s_add_u32 s28, s28, 32522240
    s_cmp_eq_u32 s20, 0
    s_cbranch_scc0 SF_36
    s_mov_b64 exec, 1
    buffer_atomic_add v7, v6, s[8:11], s28 offen
    s_mov_b64 exec, -1
SF_36:
    s_add_u32 s22, s22, s23
    s_cmp_lt_u32 s22, 64
    s_cbranch_scc1 W3_LOOP
    s_endpgm
ROLE_W4:
    v_mov_b32 v6, 0
    s_mov_b32 s29, 32505856
    s_mov_b32 s34, 0
WF_37:
    buffer_load_dword v11, v6, s[8:11], s29 offen sc1
    s_add_u32 s34, s34, 1
    s_cmp_gt_u32 s34, 4194304
    s_cbranch_scc1 TK_ABORT
    s_waitcnt vmcnt(0)
    v_cmp_gt_u32 vcc, 16, v11
    s_cbranch_vccnz WF_37
    s_lshl_b32 s24, s21, 3
    s_lshl_b32 s25, s20, 1
    s_add_u32 s24, s24, s25
    s_mul_i32 s24, s24, 14336
    s_add_u32 s25, s24, 24117248
    s_add_u32 s26, s25, 0
    buffer_load_dwordx4 a[0:3], v3, s[8:11], s26 offen offset:0
    buffer_load_dwordx4 a[4:7], v3, s[8:11], s26 offen offset:1024
    buffer_load_dwordx4 a[8:11], v3, s[8:11], s26 offen offset:2048
    buffer_load_dwordx4 a[12:15], v3, s[8:11], s26 offen offset:3072
    s_add_u32 s26, s25, 4096
    buffer_load_dwordx4 a[16:19], v3, s[8:11], s26 offen offset:0
    buffer_load_dwordx4 a[20:23], v3, s[8:11], s26 offen offset:1024
    buffer_load_dwordx4 a[24:27], v3, s[8:11], s26 offen offset:2048
    buffer_load_dwordx4 a[28:31], v3, s[8:11], s26 offen offset:3072
    s_add_u32 s26, s25, 8192
    buffer_load_dwordx4 a[32:35], v3, s[8:11], s26 offen offset:0
    buffer_load_dwordx4 a[36:39], v3, s[8:11], s26 offen offset:1024
    buffer_load_dwordx4 a[40:43], v3, s[8:11], s26 offen offset:2048
    buffer_load_dwordx4 a[44:47], v3, s[8:11], s26 offen offset:3072
    s_add_u32 s26, s25, 12288
    buffer_load_dwordx4 a[48:51], v3, s[8:11], s26 offen offset:0
    buffer_load_dwordx4 a[52:55], v3, s[8:11], s26 offen offset:1024
    buffer_load_dwordx4 a[56:59], v3, s[8:11], s26 offen offset:2048
    buffer_load_dwordx4 a[60:63], v3, s[8:11], s26 offen offset:3072
    s_add_u32 s26, s25, 16384
    buffer_load_dwordx4 a[64:67], v3, s[8:11], s26 offen offset:0
    buffer_load_dwordx4 a[68:71], v3, s[8:11], s26 offen offset:1024
    buffer_load_dwordx4 a[72:75], v3, s[8:11], s26 offen offset:2048
    buffer_load_dwordx4 a[76:79], v3, s[8:11], s26 offen offset:3072
    s_add_u32 s26, s25, 20480
    buffer_load_dwordx4 a[80:83], v3, s[8:11], s26 offen offset:0
    buffer_load_dwordx4 a[84:87], v3, s[8:11], s26 offen offset:1024
    buffer_load_dwordx4 a[88:91], v3, s[8:11], s26 offen offset:2048
    buffer_load_dwordx4 a[92:95], v3, s[8:11], s26 offen offset:3072
    s_add_u32 s26, s25, 24576
    buffer_load_dwordx4 a[96:99], v3, s[8:11], s26 offen offset:0
    buffer_load_dwordx4 a[100:103], v3, s[8:11], s26 offen offset:1024
    buffer_load_dwordx4 a[104:107], v3, s[8:11], s26 offen offset:2048
    buffer_load_dwordx4 a[108:111], v3, s[8:11], s26 offen offset:3072
    s_add_u32 s25, s24, 26214400
    s_add_u32 s26, s25, 0
    buffer_load_dwordx4 a[112:115], v3, s[8:11], s26 offen offset:0
    buffer_load_dwordx4 a[116:119], v3, s[8:11], s26 offen offset:1024
    buffer_load_dwordx4 a[120:123], v3, s[8:11], s26 offen offset:2048
    buffer_load_dwordx4 a[124:127], v3, s[8:11], s26 offen offset:3072
    s_add_u32 s26, s25, 4096
    buffer_load_dwordx4 a[128:131], v3, s[8:11], s26 offen offset:0
    buffer_load_dwordx4 a[132:135], v3, s[8:11], s26 offen offset:1024
    buffer_load_dwordx4 a[136:139], v3, s[8:11], s26 offen offset:2048
    buffer_load_dwordx4 a[140:143], v3, s[8:11], s26 offen offset:3072
    s_add_u32 s26, s25, 8192
    buffer_load_dwordx4 a[144:147], v3, s[8:11], s26 offen offset:0
    buffer_load_dwordx4 a[148:151], v3, s[8:11], s26 offen offset:1024
    buffer_load_dwordx4 a[152:155], v3, s[8:11], s26 offen offset:2048
    buffer_load_dwordx4 a[156:159], v3, s[8:11], s26 offen offset:3072
    s_add_u32 s26, s25, 12288
    buffer_load_dwordx4 a[160:163], v3, s[8:11], s26 offen offset:0
    buffer_load_dwordx4 a[164:167], v3, s[8:11], s26 offen offset:1024
    buffer_load_dwordx4 a[168:171], v3, s[8:11], s26 offen offset:2048
    buffer_load_dwordx4 a[172:175], v3, s[8:11], s26 offen offset:3072
    s_add_u32 s26, s25, 16384
    buffer_load_dwordx4 a[176:179], v3, s[8:11], s26 offen offset:0
    buffer_load_dwordx4 a[180:183], v3, s[8:11], s26 offen offset:1024
    buffer_load_dwordx4 a[184:187], v3, s[8:11], s26 offen offset:2048
    buffer_load_dwordx4 a[188:191], v3, s[8:11], s26 offen offset:3072
    s_add_u32 s26, s25, 20480
    buffer_load_dwordx4 a[192:195], v3, s[8:11], s26 offen offset:0
    buffer_load_dwordx4 a[196:199], v3, s[8:11], s26 offen offset:1024
    buffer_load_dwordx4 a[200:203], v3, s[8:11], s26 offen offset:2048
    buffer_load_dwordx4 a[204:207], v3, s[8:11], s26 offen offset:3072
    s_add_u32 s26, s25, 24576
    buffer_load_dwordx4 a[208:211], v3, s[8:11], s26 offen offset:0
    buffer_load_dwordx4 a[212:215], v3, s[8:11], s26 offen offset:1024
    buffer_load_dwordx4 a[216:219], v3, s[8:11], s26 offen offset:2048
    buffer_load_dwordx4 a[220:223], v3, s[8:11], s26 offen offset:3072
    v_and_b32 v4, 15, v2
    v_lshrrev_b32 v5, 4, v2
    v_mov_b32 v6, 0
    v_mov_b32 v7, 1
    v_lshrrev_b32 v12, 3, v0
    v_and_b32 v13, 7, v0
    v_mul_u32_u24 v8, 896, v12
    v_lshl_add_u32 v8, v13, 4, v8
    v_lshrrev_b32 v9, 2, v13
    v_lshlrev_b32 v9, 11, v9
    v_lshrrev_b32 v10, 4, v12
    v_lshl_add_u32 v9, v10, 10, v9
    v_and_b32 v10, 3, v13
    v_lshl_add_u32 v9, v10, 8, v9
    v_and_b32 v10, 15, v12
    v_lshl_add_u32 v9, v10, 4, v9
    v_lshrrev_b32 v10, 1, v5
    v_lshlrev_b32 v10, 8, v10
    v_lshl_add_u32 v10, v4, 4, v10
    v_and_b32 v11, 1, v5
    v_lshl_add_u32 v10, v11, 3, v10
    s_lshl_b32 s24, s21, 2
    s_add_u32 s24, s24, s20
    s_lshl_b32 s24, s24, 11
    v_add_u32 v10, s24, v10
W4_LOOP:
    s_lshl_b32 s28, s22, 7
    s_add_u32 s29, s28, 32522240
    s_mov_b32 s34, 0
WF_38:
    buffer_load_dword v11, v6, s[8:11], s29 offen sc1
    s_add_u32 s34, s34, 1
    s_cmp_gt_u32 s34, 4194304
    s_cbranch_scc1 TK_ABORT
    s_waitcnt vmcnt(0)
    v_cmp_gt_u32 vcc, 7, v11
    s_cbranch_vccnz WF_38
    s_mul_i32 s28, s22, 28672
    s_add_u32 s28, s28, 75497472
    buffer_load_dwordx4 v[16:19], v8, s[8:11], s28 offen offset:0 sc1
    buffer_load_dwordx4 v[20:23], v8, s[8:11], s28 offen offset:128 sc1
    buffer_load_dwordx4 v[24:27], v8, s[8:11], s28 offen offset:256 sc1
    buffer_load_dwordx4 v[28:31], v8, s[8:11], s28 offen offset:384 sc1
    buffer_load_dwordx4 v[32:35], v8, s[8:11], s28 offen offset:512 sc1
    buffer_load_dwordx4 v[36:39], v8, s[8:11], s28 offen offset:640 sc1
    buffer_load_dwordx4 v[40:43], v8, s[8:11], s28 offen offset:768 sc1
    s_waitcnt vmcnt(0)
    v_lshlrev_b32 v48, 16, v16
    v_and_b32 v49, 0xffff0000, v16
    v_lshlrev_b32 v50, 16, v17
    v_and_b32 v51, 0xffff0000, v17
    v_lshlrev_b32 v52, 16, v18
    v_and_b32 v53, 0xffff0000, v18
    v_lshlrev_b32 v54, 16, v19
    v_and_b32 v55, 0xffff0000, v19
    v_lshlrev_b32 v56, 16, v20
    v_and_b32 v57, 0xffff0000, v20
    v_lshlrev_b32 v58, 16, v21
    v_and_b32 v59, 0xffff0000, v21
    v_lshlrev_b32 v60, 16, v22
    v_and_b32 v61, 0xffff0000, v22
    v_lshlrev_b32 v62, 16, v23
    v_and_b32 v63, 0xffff0000, v23
    v_lshlrev_b32 v64, 16, v24
    v_and_b32 v65, 0xffff0000, v24
    v_lshlrev_b32 v66, 16, v25
    v_and_b32 v67, 0xffff0000, v25
    v_lshlrev_b32 v68, 16, v26
    v_and_b32 v69, 0xffff0000, v26
    v_lshlrev_b32 v70, 16, v27
    v_and_b32 v71, 0xffff0000, v27
    v_lshlrev_b32 v72, 16, v28
    v_and_b32 v73, 0xffff0000, v28
    v_lshlrev_b32 v74, 16, v29
    v_and_b32 v75, 0xffff0000, v29
    v_lshlrev_b32 v76, 16, v30
    v_and_b32 v77, 0xffff0000, v30
    v_lshlrev_b32 v78, 16, v31
    v_and_b32 v79, 0xffff0000, v31
    v_lshlrev_b32 v80, 16, v32
    v_and_b32 v81, 0xffff0000, v32
    v_lshlrev_b32 v82, 16, v33
    v_and_b32 v83, 0xffff0000, v33
    v_lshlrev_b32 v84, 16, v34
    v_and_b32 v85, 0xffff0000, v34
    v_lshlrev_b32 v86, 16, v35
    v_and_b32 v87, 0xffff0000, v35
    v_lshlrev_b32 v88, 16, v36
    v_and_b32 v89, 0xffff0000, v36
    v_lshlrev_b32 v90, 16, v37
    v_and_b32 v91, 0xffff0000, v37
    v_lshlrev_b32 v92, 16, v38
    v_and_b32 v93, 0xffff0000, v38
    v_lshlrev_b32 v94, 16, v39
    v_and_b32 v95, 0xffff0000, v39
    v_lshlrev_b32 v96, 16, v40
    v_and_b32 v97, 0xffff0000, v40
    v_lshlrev_b32 v98, 16, v41
    v_and_b32 v99, 0xffff0000, v41
    v_lshlrev_b32 v100, 16, v42
    v_and_b32 v101, 0xffff0000, v42
    v_lshlrev_b32 v102, 16, v43
    v_and_b32 v103, 0xffff0000, v43
    v_add_f32 v104, v48, v49
    v_add_f32 v104, v104, v50
    v_add_f32 v104, v104, v51
    v_add_f32 v104, v104, v52
    v_add_f32 v104, v104, v53
    v_add_f32 v104, v104, v54
    v_add_f32 v104, v104, v55
    v_add_f32 v104, v104, v56
    v_add_f32 v104, v104, v57
    v_add_f32 v104, v104, v58
    v_add_f32 v104, v104, v59
    v_add_f32 v104, v104, v60
    v_add_f32 v104, v104, v61
    v_add_f32 v104, v104, v62
    v_add_f32 v104, v104, v63
    v_add_f32 v104, v104, v64
    v_add_f32 v104, v104, v65
    v_add_f32 v104, v104, v66
    v_add_f32 v104, v104, v67
    v_add_f32 v104, v104, v68
    v_add_f32 v104, v104, v69
    v_add_f32 v104, v104, v70
    v_add_f32 v104, v104, v71
    v_add_f32 v104, v104, v72
    v_add_f32 v104, v104, v73
    v_add_f32 v104, v104, v74
    v_add_f32 v104, v104, v75
    v_add_f32 v104, v104, v76
    v_add_f32 v104, v104, v77
    v_add_f32 v104, v104, v78
    v_add_f32 v104, v104, v79
    v_add_f32 v104, v104, v80
    v_add_f32 v104, v104, v81
    v_add_f32 v104, v104, v82
    v_add_f32 v104, v104, v83
    v_add_f32 v104, v104, v84
    v_add_f32 v104, v104, v85
    v_add_f32 v104, v104, v86
    v_add_f32 v104, v104, v87
    v_add_f32 v104, v104, v88
    v_add_f32 v104, v104, v89
    v_add_f32 v104, v104, v90
    v_add_f32 v104, v104, v91
    v_add_f32 v104, v104, v92
    v_add_f32 v104, v104, v93
    v_add_f32 v104, v104, v94
    v_add_f32 v104, v104, v95
    v_add_f32 v104, v104, v96
    v_add_f32 v104, v104, v97
    v_add_f32 v104, v104, v98
    v_add_f32 v104, v104, v99
    v_add_f32 v104, v104, v100
    v_add_f32 v104, v104, v101
    v_add_f32 v104, v104, v102
    v_add_f32 v104, v104, v103
    s_nop 1
    v_add_f32_dpp v104, v104, v104 quad_perm:[1,0,3,2] row_mask:0xf bank_mask:0xf
    s_nop 1
    v_add_f32_dpp v104, v104, v104 quad_perm:[2,3,0,1] row_mask:0xf bank_mask:0xf
    s_nop 1
    v_add_f32_dpp v104, v104, v104 row_half_mirror row_mask:0xf bank_mask:0xf
    s_nop 1
    v_mul_f32 v104, 0.002232142857142857, v104
    v_mov_b32 v105, 0
    v_sub_f32 v106, v48, v104
    v_fmac_f32 v105, v106, v106
    v_sub_f32 v106, v49, v104
    v_fmac_f32 v105, v106, v106
    v_sub_f32 v106, v50, v104
    v_fmac_f32 v105, v106, v106
    v_sub_f32 v106, v51, v104
    v_fmac_f32 v105, v106, v106
    v_sub_f32 v106, v52, v104
    v_fmac_f32 v105, v106, v106
    v_sub_f32 v106, v53, v104
    v_fmac_f32 v105, v106, v106
    v_sub_f32 v106, v54, v104
    v_fmac_f32 v105, v106, v106
    v_sub_f32 v106, v55, v104
    v_fmac_f32 v105, v106, v106
    v_sub_f32 v106, v56, v104
    v_fmac_f32 v105, v106, v106
    v_sub_f32 v106, v57, v104
    v_fmac_f32 v105, v106, v106
    v_sub_f32 v106, v58, v104
    v_fmac_f32 v105, v106, v106
    v_sub_f32 v106, v59, v104
    v_fmac_f32 v105, v106, v106
    v_sub_f32 v106, v60, v104
    v_fmac_f32 v105, v106, v106
    v_sub_f32 v106, v61, v104
    v_fmac_f32 v105, v106, v106
    v_sub_f32 v106, v62, v104
    v_fmac_f32 v105, v106, v106
    v_sub_f32 v106, v63, v104
    v_fmac_f32 v105, v106, v106
    v_sub_f32 v106, v64, v104
    v_fmac_f32 v105, v106, v106
    v_sub_f32 v106, v65, v104
    v_fmac_f32 v105, v106, v106
    v_sub_f32 v106, v66, v104
    v_fmac_f32 v105, v106, v106
    v_sub_f32 v106, v67, v104
    v_fmac_f32 v105, v106, v106
    v_sub_f32 v106, v68, v104
    v_fmac_f32 v105, v106, v106
    v_sub_f32 v106, v69, v104
    v_fmac_f32 v105, v106, v106
    v_sub_f32 v106, v70, v104
    v_fmac_f32 v105, v106, v106
    v_sub_f32 v106, v71, v104
    v_fmac_f32 v105, v106, v106
    v_sub_f32 v106, v72, v104
    v_fmac_f32 v105, v106, v106
    v_sub_f32 v106, v73, v104
    v_fmac_f32 v105, v106, v106
    v_sub_f32 v106, v74, v104
    v_fmac_f32 v105, v106, v106
    v_sub_f32 v106, v75, v104
    v_fmac_f32 v105, v106, v106
    v_sub_f32 v106, v76, v104
    v_fmac_f32 v105, v106, v106
    v_sub_f32 v106, v77, v104
    v_fmac_f32 v105, v106, v106
    v_sub_f32 v106, v78, v104
    v_fmac_f32 v105, v106, v106
    v_sub_f32 v106, v79, v104
    v_fmac_f32 v105, v106, v106
    v_sub_f32 v106, v80, v104
    v_fmac_f32 v105, v106, v106
    v_sub_f32 v106, v81, v104
    v_fmac_f32 v105, v106, v106
    v_sub_f32 v106, v82, v104
    v_fmac_f32 v105, v106, v106
    v_sub_f32 v106, v83, v104
    v_fmac_f32 v105, v106, v106
    v_sub_f32 v106, v84, v104
    v_fmac_f32 v105, v106, v106
    v_sub_f32 v106, v85, v104
    v_fmac_f32 v105, v106, v106
    v_sub_f32 v106, v86, v104
    v_fmac_f32 v105, v106, v106
    v_sub_f32 v106, v87, v104
    v_fmac_f32 v105, v106, v106
    v_sub_f32 v106, v88, v104
    v_fmac_f32 v105, v106, v106
    v_sub_f32 v106, v89, v104
    v_fmac_f32 v105, v106, v106
    v_sub_f32 v106, v90, v104
    v_fmac_f32 v105, v106, v106
    v_sub_f32 v106, v91, v104
    v_fmac_f32 v105, v106, v106
    v_sub_f32 v106, v92, v104
    v_fmac_f32 v105, v106, v106
    v_sub_f32 v106, v93, v104
    v_fmac_f32 v105, v106, v106
    v_sub_f32 v106, v94, v104
    v_fmac_f32 v105, v106, v106
    v_sub_f32 v106, v95, v104
    v_fmac_f32 v105, v106, v106
    v_sub_f32 v106, v96, v104
    v_fmac_f32 v105, v106, v106
    v_sub_f32 v106, v97, v104
    v_fmac_f32 v105, v106, v106
    v_sub_f32 v106, v98, v104
    v_fmac_f32 v105, v106, v106
    v_sub_f32 v106, v99, v104
    v_fmac_f32 v105, v106, v106
    v_sub_f32 v106, v100, v104
    v_fmac_f32 v105, v106, v106
    v_sub_f32 v106, v101, v104
    v_fmac_f32 v105, v106, v106
    v_sub_f32 v106, v102, v104
    v_fmac_f32 v105, v106, v106
    v_sub_f32 v106, v103, v104
    v_fmac_f32 v105, v106, v106
    s_nop 1
    v_add_f32_dpp v105, v105, v105 quad_perm:[1,0,3,2] row_mask:0xf bank_mask:0xf
    s_nop 1
    v_add_f32_dpp v105, v105, v105 quad_perm:[2,3,0,1] row_mask:0xf bank_mask:0xf
    s_nop 1
    v_add_f32_dpp v105, v105, v105 row_half_mirror row_mask:0xf bank_mask:0xf
    s_nop 1
    v_mul_f32 v105, 0.002232142857142857, v105
    v_cvt_pk_bf16_f32 v104, v104, v105
    v_and_b32 v105, 0xffff0000, v104
    v_lshlrev_b32 v104, 16, v104
    v_add_f32 v105, 0x3727c5ac, v105
    v_cvt_pk_bf16_f32 v105, v105, v105
    v_lshlrev_b32 v105, 16, v105
    v_sqrt_f32 v105, v105
    s_nop 0
    v_cvt_pk_bf16_f32 v105, v105, v105
    v_lshlrev_b32 v105, 16, v105
    v_rcp_f32 v105, v105
    v_sub_f32 v106, v48, v104
    v_sub_f32 v107, v49, v104
    v_cvt_pk_bf16_f32 v106, v106, v107
    v_and_b32 v107, 0xffff0000, v106
    v_lshlrev_b32 v106, 16, v106
    v_mul_f32 v106, v106, v105
    v_mul_f32 v107, v107, v105
    v_cvt_pk_bf16_f32 v16, v106, v107
    v_sub_f32 v106, v50, v104
    v_sub_f32 v107, v51, v104
    v_cvt_pk_bf16_f32 v106, v106, v107
    v_and_b32 v107, 0xffff0000, v106
    v_lshlrev_b32 v106, 16, v106
    v_mul_f32 v106, v106, v105
    v_mul_f32 v107, v107, v105
    v_cvt_pk_bf16_f32 v17, v106, v107
    v_sub_f32 v106, v52, v104
    v_sub_f32 v107, v53, v104
    v_cvt_pk_bf16_f32 v106, v106, v107
    v_and_b32 v107, 0xffff0000, v106
    v_lshlrev_b32 v106, 16, v106
    v_mul_f32 v106, v106, v105
    v_mul_f32 v107, v107, v105
    v_cvt_pk_bf16_f32 v18, v106, v107
    v_sub_f32 v106, v54, v104
    v_sub_f32 v107, v55, v104
    v_cvt_pk_bf16_f32 v106, v106, v107
    v_and_b32 v107, 0xffff0000, v106
    v_lshlrev_b32 v106, 16, v106
    v_mul_f32 v106, v106, v105
    v_mul_f32 v107, v107, v105
    v_cvt_pk_bf16_f32 v19, v106, v107
    v_sub_f32 v106, v56, v104
    v_sub_f32 v107, v57, v104
    v_cvt_pk_bf16_f32 v106, v106, v107
    v_and_b32 v107, 0xffff0000, v106
    v_lshlrev_b32 v106, 16, v106
    v_mul_f32 v106, v106, v105
    v_mul_f32 v107, v107, v105
    v_cvt_pk_bf16_f32 v20, v106, v107
    v_sub_f32 v106, v58, v104
    v_sub_f32 v107, v59, v104
    v_cvt_pk_bf16_f32 v106, v106, v107
    v_and_b32 v107, 0xffff0000, v106
    v_lshlrev_b32 v106, 16, v106
    v_mul_f32 v106, v106, v105
    v_mul_f32 v107, v107, v105
    v_cvt_pk_bf16_f32 v21, v106, v107
    v_sub_f32 v106, v60, v104
    v_sub_f32 v107, v61, v104
    v_cvt_pk_bf16_f32 v106, v106, v107
    v_and_b32 v107, 0xffff0000, v106
    v_lshlrev_b32 v106, 16, v106
    v_mul_f32 v106, v106, v105
    v_mul_f32 v107, v107, v105
    v_cvt_pk_bf16_f32 v22, v106, v107
    v_sub_f32 v106, v62, v104
    v_sub_f32 v107, v63, v104
    v_cvt_pk_bf16_f32 v106, v106, v107
    v_and_b32 v107, 0xffff0000, v106
    v_lshlrev_b32 v106, 16, v106
    v_mul_f32 v106, v106, v105
    v_mul_f32 v107, v107, v105
    v_cvt_pk_bf16_f32 v23, v106, v107
    v_sub_f32 v106, v64, v104
    v_sub_f32 v107, v65, v104
    v_cvt_pk_bf16_f32 v106, v106, v107
    v_and_b32 v107, 0xffff0000, v106
    v_lshlrev_b32 v106, 16, v106
    v_mul_f32 v106, v106, v105
    v_mul_f32 v107, v107, v105
    v_cvt_pk_bf16_f32 v24, v106, v107
    v_sub_f32 v106, v66, v104
    v_sub_f32 v107, v67, v104
    v_cvt_pk_bf16_f32 v106, v106, v107
    v_and_b32 v107, 0xffff0000, v106
    v_lshlrev_b32 v106, 16, v106
    v_mul_f32 v106, v106, v105
    v_mul_f32 v107, v107, v105
    v_cvt_pk_bf16_f32 v25, v106, v107
    v_sub_f32 v106, v68, v104
    v_sub_f32 v107, v69, v104
    v_cvt_pk_bf16_f32 v106, v106, v107
    v_and_b32 v107, 0xffff0000, v106
    v_lshlrev_b32 v106, 16, v106
    v_mul_f32 v106, v106, v105
    v_mul_f32 v107, v107, v105
    v_cvt_pk_bf16_f32 v26, v106, v107
    v_sub_f32 v106, v70, v104
    v_sub_f32 v107, v71, v104
    v_cvt_pk_bf16_f32 v106, v106, v107
    v_and_b32 v107, 0xffff0000, v106
    v_lshlrev_b32 v106, 16, v106
    v_mul_f32 v106, v106, v105
    v_mul_f32 v107, v107, v105
    v_cvt_pk_bf16_f32 v27, v106, v107
    v_sub_f32 v106, v72, v104
    v_sub_f32 v107, v73, v104
    v_cvt_pk_bf16_f32 v106, v106, v107
    v_and_b32 v107, 0xffff0000, v106
    v_lshlrev_b32 v106, 16, v106
    v_mul_f32 v106, v106, v105
    v_mul_f32 v107, v107, v105
    v_cvt_pk_bf16_f32 v28, v106, v107
    v_sub_f32 v106, v74, v104
    v_sub_f32 v107, v75, v104
    v_cvt_pk_bf16_f32 v106, v106, v107
    v_and_b32 v107, 0xffff0000, v106
    v_lshlrev_b32 v106, 16, v106
    v_mul_f32 v106, v106, v105
    v_mul_f32 v107, v107, v105
    v_cvt_pk_bf16_f32 v29, v106, v107
    v_sub_f32 v106, v76, v104
    v_sub_f32 v107, v77, v104
    v_cvt_pk_bf16_f32 v106, v106, v107
    v_and_b32 v107, 0xffff0000, v106
    v_lshlrev_b32 v106, 16, v106
    v_mul_f32 v106, v106, v105
    v_mul_f32 v107, v107, v105
    v_cvt_pk_bf16_f32 v30, v106, v107
    v_sub_f32 v106, v78, v104
    v_sub_f32 v107, v79, v104
    v_cvt_pk_bf16_f32 v106, v106, v107
    v_and_b32 v107, 0xffff0000, v106
    v_lshlrev_b32 v106, 16, v106
    v_mul_f32 v106, v106, v105
    v_mul_f32 v107, v107, v105
    v_cvt_pk_bf16_f32 v31, v106, v107
    v_sub_f32 v106, v80, v104
    v_sub_f32 v107, v81, v104
    v_cvt_pk_bf16_f32 v106, v106, v107
    v_and_b32 v107, 0xffff0000, v106
    v_lshlrev_b32 v106, 16, v106
    v_mul_f32 v106, v106, v105
    v_mul_f32 v107, v107, v105
    v_cvt_pk_bf16_f32 v32, v106, v107
    v_sub_f32 v106, v82, v104
    v_sub_f32 v107, v83, v104
    v_cvt_pk_bf16_f32 v106, v106, v107
    v_and_b32 v107, 0xffff0000, v106
    v_lshlrev_b32 v106, 16, v106
    v_mul_f32 v106, v106, v105
    v_mul_f32 v107, v107, v105
    v_cvt_pk_bf16_f32 v33, v106, v107
    v_sub_f32 v106, v84, v104
    v_sub_f32 v107, v85, v104
    v_cvt_pk_bf16_f32 v106, v106, v107
    v_and_b32 v107, 0xffff0000, v106
    v_lshlrev_b32 v106, 16, v106
    v_mul_f32 v106, v106, v105
    v_mul_f32 v107, v107, v105
    v_cvt_pk_bf16_f32 v34, v106, v107
    v_sub_f32 v106, v86, v104
    v_sub_f32 v107, v87, v104
    v_cvt_pk_bf16_f32 v106, v106, v107
    v_and_b32 v107, 0xffff0000, v106
    v_lshlrev_b32 v106, 16, v106
    v_mul_f32 v106, v106, v105
    v_mul_f32 v107, v107, v105
    v_cvt_pk_bf16_f32 v35, v106, v107
    v_sub_f32 v106, v88, v104
    v_sub_f32 v107, v89, v104
    v_cvt_pk_bf16_f32 v106, v106, v107
    v_and_b32 v107, 0xffff0000, v106
    v_lshlrev_b32 v106, 16, v106
    v_mul_f32 v106, v106, v105
    v_mul_f32 v107, v107, v105
    v_cvt_pk_bf16_f32 v36, v106, v107
    v_sub_f32 v106, v90, v104
    v_sub_f32 v107, v91, v104
    v_cvt_pk_bf16_f32 v106, v106, v107
    v_and_b32 v107, 0xffff0000, v106
    v_lshlrev_b32 v106, 16, v106
    v_mul_f32 v106, v106, v105
    v_mul_f32 v107, v107, v105
    v_cvt_pk_bf16_f32 v37, v106, v107
    v_sub_f32 v106, v92, v104
    v_sub_f32 v107, v93, v104
    v_cvt_pk_bf16_f32 v106, v106, v107
    v_and_b32 v107, 0xffff0000, v106
    v_lshlrev_b32 v106, 16, v106
    v_mul_f32 v106, v106, v105
    v_mul_f32 v107, v107, v105
    v_cvt_pk_bf16_f32 v38, v106, v107
    v_sub_f32 v106, v94, v104
    v_sub_f32 v107, v95, v104
    v_cvt_pk_bf16_f32 v106, v106, v107
    v_and_b32 v107, 0xffff0000, v106
    v_lshlrev_b32 v106, 16, v106
    v_mul_f32 v106, v106, v105
    v_mul_f32 v107, v107, v105
    v_cvt_pk_bf16_f32 v39, v106, v107
    v_sub_f32 v106, v96, v104
    v_sub_f32 v107, v97, v104
    v_cvt_pk_bf16_f32 v106, v106, v107
    v_and_b32 v107, 0xffff0000, v106
    v_lshlrev_b32 v106, 16, v106
    v_mul_f32 v106, v106, v105
    v_mul_f32 v107, v107, v105
    v_cvt_pk_bf16_f32 v40, v106, v107
    v_sub_f32 v106, v98, v104
    v_sub_f32 v107, v99, v104
    v_cvt_pk_bf16_f32 v106, v106, v107
    v_and_b32 v107, 0xffff0000, v106
    v_lshlrev_b32 v106, 16, v106
    v_mul_f32 v106, v106, v105
    v_mul_f32 v107, v107, v105
    v_cvt_pk_bf16_f32 v41, v106, v107
    v_sub_f32 v106, v100, v104
    v_sub_f32 v107, v101, v104
    v_cvt_pk_bf16_f32 v106, v106, v107
    v_and_b32 v107, 0xffff0000, v106
    v_lshlrev_b32 v106, 16, v106
    v_mul_f32 v106, v106, v105
    v_mul_f32 v107, v107, v105
    v_cvt_pk_bf16_f32 v42, v106, v107
    v_sub_f32 v106, v102, v104
    v_sub_f32 v107, v103, v104
    v_cvt_pk_bf16_f32 v106, v106, v107
    v_and_b32 v107, 0xffff0000, v106
    v_lshlrev_b32 v106, 16, v106
    v_mul_f32 v106, v106, v105
    v_mul_f32 v107, v107, v105
    v_cvt_pk_bf16_f32 v43, v106, v107
    ds_write_b128 v9, v[16:19] offset:0
    ds_write_b128 v9, v[20:23] offset:4096
    ds_write_b128 v9, v[24:27] offset:8192
    ds_write_b128 v9, v[28:31] offset:12288
    ds_write_b128 v9, v[32:35] offset:16384
    ds_write_b128 v9, v[36:39] offset:20480
    ds_write_b128 v9, v[40:43] offset:24576
    s_waitcnt lgkmcnt(0)
    s_barrier
    ds_read_b128 v[48:51], v3 offset:0
    ds_read_b128 v[52:55], v3 offset:1024
    ds_read_b128 v[56:59], v3 offset:2048
    ds_read_b128 v[60:63], v3 offset:3072
    s_waitcnt lgkmcnt(2)
    v_mfma_f32_16x16x32_bf16 v[64:67], a[0:3], v[48:51], 0
    v_mfma_f32_16x16x32_bf16 v[68:71], a[0:3], v[52:55], 0
    v_mfma_f32_16x16x32_bf16 v[72:75], a[56:59], v[48:51], 0
    v_mfma_f32_16x16x32_bf16 v[76:79], a[56:59], v[52:55], 0
    v_mfma_f32_16x16x32_bf16 v[80:83], a[112:115], v[48:51], 0
    v_mfma_f32_16x16x32_bf16 v[84:87], a[112:115], v[52:55], 0
    v_mfma_f32_16x16x32_bf16 v[88:91], a[168:171], v[48:51], 0
    v_mfma_f32_16x16x32_bf16 v[92:95], a[168:171], v[52:55], 0
    ds_read_b128 v[48:51], v3 offset:4096
    ds_read_b128 v[52:55], v3 offset:5120
    s_waitcnt lgkmcnt(2)
    v_mfma_f32_16x16x32_bf16 v[64:67], a[4:7], v[56:59], v[64:67]
    v_mfma_f32_16x16x32_bf16 v[68:71], a[4:7], v[60:63], v[68:71]
    v_mfma_f32_16x16x32_bf16 v[72:75], a[60:63], v[56:59], v[72:75]
    v_mfma_f32_16x16x32_bf16 v[76:79], a[60:63], v[60:63], v[76:79]
    v_mfma_f32_16x16x32_bf16 v[80:83], a[116:119], v[56:59], v[80:83]
    v_mfma_f32_16x16x32_bf16 v[84:87], a[116:119], v[60:63], v[84:87]
    v_mfma_f32_16x16x32_bf16 v[88:91], a[172:175], v[56:59], v[88:91]
    v_mfma_f32_16x16x32_bf16 v[92:95], a[172:175], v[60:63], v[92:95]
    ds_read_b128 v[56:59], v3 offset:6144
    ds_read_b128 v[60:63], v3 offset:7168
    s_waitcnt lgkmcnt(2)
    v_mfma_f32_16x16x32_bf16 v[64:67], a[8:11], v[48:51], v[64:67]
    v_mfma_f32_16x16x32_bf16 v[68:71], a[8:11], v[52:55], v[68:71]
    v_mfma_f32_16x16x32_bf16 v[72:75], a[64:67], v[48:51], v[72:75]
    v_mfma_f32_16x16x32_bf16 v[76:79], a[64:67], v[52:55], v[76:79]
    v_mfma_f32_16x16x32_bf16 v[80:83], a[120:123], v[48:51], v[80:83]
    v_mfma_f32_16x16x32_bf16 v[84:87], a[120:123], v[52:55], v[84:87]
    v_mfma_f32_16x16x32_bf16 v[88:91], a[176:179], v[48:51], v[88:91]
    v_mfma_f32_16x16x32_bf16 v[92:95], a[176:179], v[52:55], v[92:95]
    ds_read_b128 v[48:51], v3 offset:8192
    ds_read_b128 v[52:55], v3 offset:9216
    s_waitcnt lgkmcnt(2)
    v_mfma_f32_16x16x32_bf16 v[64:67], a[12:15], v[56:59], v[64:67]
    v_mfma_f32_16x16x32_bf16 v[68:71], a[12:15], v[60:63], v[68:71]
    v_mfma_f32_16x16x32_bf16 v[72:75], a[68:71], v[56:59], v[72:75]
    v_mfma_f32_16x16x32_bf16 v[76:79], a[68:71], v[60:63], v[76:79]
    v_mfma_f32_16x16x32_bf16 v[80:83], a[124:127], v[56:59], v[80:83]
    v_mfma_f32_16x16x32_bf16 v[84:87], a[124:127], v[60:63], v[84:87]
    v_mfma_f32_16x16x32_bf16 v[88:91], a[180:183], v[56:59], v[88:91]
    v_mfma_f32_16x16x32_bf16 v[92:95], a[180:183], v[60:63], v[92:95]
    ds_read_b128 v[56:59], v3 offset:10240
    ds_read_b128 v[60:63], v3 offset:11264
    s_waitcnt lgkmcnt(2)
    v_mfma_f32_16x16x32_bf16 v[64:67], a[16:19], v[48:51], v[64:67]
    v_mfma_f32_16x16x32_bf16 v[68:71], a[16:19], v[52:55], v[68:71]
    v_mfma_f32_16x16x32_bf16 v[72:75], a[72:75], v[48:51], v[72:75]
    v_mfma_f32_16x16x32_bf16 v[76:79], a[72:75], v[52:55], v[76:79]
    v_mfma_f32_16x16x32_bf16 v[80:83], a[128:131], v[48:51], v[80:83]
    v_mfma_f32_16x16x32_bf16 v[84:87], a[128:131], v[52:55], v[84:87]
    v_mfma_f32_16x16x32_bf16 v[88:91], a[184:187], v[48:51], v[88:91]
    v_mfma_f32_16x16x32_bf16 v[92:95], a[184:187], v[52:55], v[92:95]
    ds_read_b128 v[48:51], v3 offset:12288
    ds_read_b128 v[52:55], v3 offset:13312
    s_waitcnt lgkmcnt(2)
    v_mfma_f32_16x16x32_bf16 v[64:67], a[20:23], v[56:59], v[64:67]
    v_mfma_f32_16x16x32_bf16 v[68:71], a[20:23], v[60:63], v[68:71]
    v_mfma_f32_16x16x32_bf16 v[72:75], a[76:79], v[56:59], v[72:75]
    v_mfma_f32_16x16x32_bf16 v[76:79], a[76:79], v[60:63], v[76:79]
    v_mfma_f32_16x16x32_bf16 v[80:83], a[132:135], v[56:59], v[80:83]
    v_mfma_f32_16x16x32_bf16 v[84:87], a[132:135], v[60:63], v[84:87]
    v_mfma_f32_16x16x32_bf16 v[88:91], a[188:191], v[56:59], v[88:91]
    v_mfma_f32_16x16x32_bf16 v[92:95], a[188:191], v[60:63], v[92:95]
    ds_read_b128 v[56:59], v3 offset:14336
    ds_read_b128 v[60:63], v3 offset:15360
    s_waitcnt lgkmcnt(2)
    v_mfma_f32_16x16x32_bf16 v[64:67], a[24:27], v[48:51], v[64:67]
    v_mfma_f32_16x16x32_bf16 v[68:71], a[24:27], v[52:55], v[68:71]
    v_mfma_f32_16x16x32_bf16 v[72:75], a[80:83], v[48:51], v[72:75]
    v_mfma_f32_16x16x32_bf16 v[76:79], a[80:83], v[52:55], v[76:79]
    v_mfma_f32_16x16x32_bf16 v[80:83], a[136:139], v[48:51], v[80:83]
    v_mfma_f32_16x16x32_bf16 v[84:87], a[136:139], v[52:55], v[84:87]
    v_mfma_f32_16x16x32_bf16 v[88:91], a[192:195], v[48:51], v[88:91]
    v_mfma_f32_16x16x32_bf16 v[92:95], a[192:195], v[52:55], v[92:95]
    ds_read_b128 v[48:51], v3 offset:16384
    ds_read_b128 v[52:55], v3 offset:17408
    s_waitcnt lgkmcnt(2)
    v_mfma_f32_16x16x32_bf16 v[64:67], a[28:31], v[56:59], v[64:67]
    v_mfma_f32_16x16x32_bf16 v[68:71], a[28:31], v[60:63], v[68:71]
    v_mfma_f32_16x16x32_bf16 v[72:75], a[84:87], v[56:59], v[72:75]
    v_mfma_f32_16x16x32_bf16 v[76:79], a[84:87], v[60:63], v[76:79]
    v_mfma_f32_16x16x32_bf16 v[80:83], a[140:143], v[56:59], v[80:83]
    v_mfma_f32_16x16x32_bf16 v[84:87], a[140:143], v[60:63], v[84:87]
    v_mfma_f32_16x16x32_bf16 v[88:91], a[196:199], v[56:59], v[88:91]
    v_mfma_f32_16x16x32_bf16 v[92:95], a[196:199], v[60:63], v[92:95]
    ds_read_b128 v[56:59], v3 offset:18432
    ds_read_b128 v[60:63], v3 offset:19456
    s_waitcnt lgkmcnt(2)
    v_mfma_f32_16x16x32_bf16 v[64:67], a[32:35], v[48:51], v[64:67]
    v_mfma_f32_16x16x32_bf16 v[68:71], a[32:35], v[52:55], v[68:71]
    v_mfma_f32_16x16x32_bf16 v[72:75], a[88:91], v[48:51], v[72:75]
    v_mfma_f32_16x16x32_bf16 v[76:79], a[88:91], v[52:55], v[76:79]
    v_mfma_f32_16x16x32_bf16 v[80:83], a[144:147], v[48:51], v[80:83]
    v_mfma_f32_16x16x32_bf16 v[84:87], a[144:147], v[52:55], v[84:87]
    v_mfma_f32_16x16x32_bf16 v[88:91], a[200:203], v[48:51], v[88:91]
    v_mfma_f32_16x16x32_bf16 v[92:95], a[200:203], v[52:55], v[92:95]
    ds_read_b128 v[48:51], v3 offset:20480
    ds_read_b128 v[52:55], v3 offset:21504
    s_waitcnt lgkmcnt(2)
    v_mfma_f32_16x16x32_bf16 v[64:67], a[36:39], v[56:59], v[64:67]
    v_mfma_f32_16x16x32_bf16 v[68:71], a[36:39], v[60:63], v[68:71]
    v_mfma_f32_16x16x32_bf16 v[72:75], a[92:95], v[56:59], v[72:75]
    v_mfma_f32_16x16x32_bf16 v[76:79], a[92:95], v[60:63], v[76:79]
    v_mfma_f32_16x16x32_bf16 v[80:83], a[148:151], v[56:59], v[80:83]
    v_mfma_f32_16x16x32_bf16 v[84:87], a[148:151], v[60:63], v[84:87]
    v_mfma_f32_16x16x32_bf16 v[88:91], a[204:207], v[56:59], v[88:91]
    v_mfma_f32_16x16x32_bf16 v[92:95], a[204:207], v[60:63], v[92:95]
    ds_read_b128 v[56:59], v3 offset:22528
    ds_read_b128 v[60:63], v3 offset:23552
    s_waitcnt lgkmcnt(2)
    v_mfma_f32_16x16x32_bf16 v[64:67], a[40:43], v[48:51], v[64:67]
    v_mfma_f32_16x16x32_bf16 v[68:71], a[40:43], v[52:55], v[68:71]
    v_mfma_f32_16x16x32_bf16 v[72:75], a[96:99], v[48:51], v[72:75]
    v_mfma_f32_16x16x32_bf16 v[76:79], a[96:99], v[52:55], v[76:79]
    v_mfma_f32_16x16x32_bf16 v[80:83], a[152:155], v[48:51], v[80:83]
    v_mfma_f32_16x16x32_bf16 v[84:87], a[152:155], v[52:55], v[84:87]
    v_mfma_f32_16x16x32_bf16 v[88:91], a[208:211], v[48:51], v[88:91]
    v_mfma_f32_16x16x32_bf16 v[92:95], a[208:211], v[52:55], v[92:95]
    ds_read_b128 v[48:51], v3 offset:24576
    ds_read_b128 v[52:55], v3 offset:25600
    s_waitcnt lgkmcnt(2)
    v_mfma_f32_16x16x32_bf16 v[64:67], a[44:47], v[56:59], v[64:67]
    v_mfma_f32_16x16x32_bf16 v[68:71], a[44:47], v[60:63], v[68:71]
    v_mfma_f32_16x16x32_bf16 v[72:75], a[100:103], v[56:59], v[72:75]
    v_mfma_f32_16x16x32_bf16 v[76:79], a[100:103], v[60:63], v[76:79]
    v_mfma_f32_16x16x32_bf16 v[80:83], a[156:159], v[56:59], v[80:83]
    v_mfma_f32_16x16x32_bf16 v[84:87], a[156:159], v[60:63], v[84:87]
    v_mfma_f32_16x16x32_bf16 v[88:91], a[212:215], v[56:59], v[88:91]
    v_mfma_f32_16x16x32_bf16 v[92:95], a[212:215], v[60:63], v[92:95]
    ds_read_b128 v[56:59], v3 offset:26624
    ds_read_b128 v[60:63], v3 offset:27648
    s_waitcnt lgkmcnt(2)
    v_mfma_f32_16x16x32_bf16 v[64:67], a[48:51], v[48:51], v[64:67]
    v_mfma_f32_16x16x32_bf16 v[68:71], a[48:51], v[52:55], v[68:71]
    v_mfma_f32_16x16x32_bf16 v[72:75], a[104:107], v[48:51], v[72:75]
    v_mfma_f32_16x16x32_bf16 v[76:79], a[104:107], v[52:55], v[76:79]
    v_mfma_f32_16x16x32_bf16 v[80:83], a[160:163], v[48:51], v[80:83]
    v_mfma_f32_16x16x32_bf16 v[84:87], a[160:163], v[52:55], v[84:87]
    v_mfma_f32_16x16x32_bf16 v[88:91], a[216:219], v[48:51], v[88:91]
    v_mfma_f32_16x16x32_bf16 v[92:95], a[216:219], v[52:55], v[92:95]
    s_waitcnt lgkmcnt(0)
    v_mfma_f32_16x16x32_bf16 v[64:67], a[52:55], v[56:59], v[64:67]
    v_mfma_f32_16x16x32_bf16 v[68:71], a[52:55], v[60:63], v[68:71]
    v_mfma_f32_16x16x32_bf16 v[72:75], a[108:111], v[56:59], v[72:75]
    v_mfma_f32_16x16x32_bf16 v[76:79], a[108:111], v[60:63], v[76:79]
    v_mfma_f32_16x16x32_bf16 v[80:83], a[164:167], v[56:59], v[80:83]
    v_mfma_f32_16x16x32_bf16 v[84:87], a[164:167], v[60:63], v[84:87]
    v_mfma_f32_16x16x32_bf16 v[88:91], a[220:223], v[56:59], v[88:91]
    v_mfma_f32_16x16x32_bf16 v[92:95], a[220:223], v[60:63], v[92:95]
    s_nop 7
    s_nop 1
    s_mul_i32 s28, s22, 114688
    s_add_u32 s28, s28, 77594624
    v_cvt_pk_bf16_f32 v16, v64, v65
    v_cvt_pk_bf16_f32 v17, v80, v81
    v_lshlrev_b32 v18, 16, v16
    v_and_b32 v19, 0xffff0000, v16
    v_lshlrev_b32 v20, 16, v17
    v_and_b32 v21, 0xffff0000, v17
    v_max_f32 v18, 0, v18
    v_max_f32 v19, 0, v19
    v_mul_f32 v18, v18, v20
    v_mul_f32 v19, v19, v21
    v_cvt_pk_bf16_f32 v22, v18, v19
    v_cvt_pk_bf16_f32 v16, v66, v67
    v_cvt_pk_bf16_f32 v17, v82, v83
    v_lshlrev_b32 v18, 16, v16
    v_and_b32 v19, 0xffff0000, v16
    v_lshlrev_b32 v20, 16, v17
    v_and_b32 v21, 0xffff0000, v17
    v_max_f32 v18, 0, v18
    v_max_f32 v19, 0, v19
    v_mul_f32 v18, v18, v20
    v_mul_f32 v19, v19, v21
    v_cvt_pk_bf16_f32 v23, v18, v19
    buffer_store_dwordx2 v[22:23], v10, s[8:11], s28 offen offset:0 sc1
    s_nop 1
    v_cvt_pk_bf16_f32 v16, v68, v69
    v_cvt_pk_bf16_f32 v17, v84, v85
    v_lshlrev_b32 v18, 16, v16
    v_and_b32 v19, 0xffff0000, v16
    v_lshlrev_b32 v20, 16, v17
    v_and_b32 v21, 0xffff0000, v17
    v_max_f32 v18, 0, v18
    v_max_f32 v19, 0, v19
    v_mul_f32 v18, v18, v20
    v_mul_f32 v19, v19, v21
    v_cvt_pk_bf16_f32 v22, v18, v19
    v_cvt_pk_bf16_f32 v16, v70, v71
    v_cvt_pk_bf16_f32 v17, v86, v87
    v_lshlrev_b32 v18, 16, v16
    v_and_b32 v19, 0xffff0000, v16
    v_lshlrev_b32 v20, 16, v17
    v_and_b32 v21, 0xffff0000, v17
    v_max_f32 v18, 0, v18
    v_max_f32 v19, 0, v19
    v_mul_f32 v18, v18, v20
    v_mul_f32 v19, v19, v21
    v_cvt_pk_bf16_f32 v23, v18, v19
    buffer_store_dwordx2 v[22:23], v10, s[8:11], s28 offen offset:1024 sc1
    s_nop 1
    v_cvt_pk_bf16_f32 v16, v72, v73
    v_cvt_pk_bf16_f32 v17, v88, v89
    v_lshlrev_b32 v18, 16, v16
    v_and_b32 v19, 0xffff0000, v16
    v_lshlrev_b32 v20, 16, v17
    v_and_b32 v21, 0xffff0000, v17
    v_max_f32 v18, 0, v18
    v_max_f32 v19, 0, v19
    v_mul_f32 v18, v18, v20
    v_mul_f32 v19, v19, v21
    v_cvt_pk_bf16_f32 v22, v18, v19
    v_cvt_pk_bf16_f32 v16, v74, v75
    v_cvt_pk_bf16_f32 v17, v90, v91
    v_lshlrev_b32 v18, 16, v16
    v_and_b32 v19, 0xffff0000, v16
    v_lshlrev_b32 v20, 16, v17
    v_and_b32 v21, 0xffff0000, v17
    v_max_f32 v18, 0, v18
    v_max_f32 v19, 0, v19
    v_mul_f32 v18, v18, v20
    v_mul_f32 v19, v19, v21
    v_cvt_pk_bf16_f32 v23, v18, v19
    buffer_store_dwordx2 v[22:23], v10, s[8:11], s28 offen offset:512 sc1
    s_nop 1
    v_cvt_pk_bf16_f32 v16, v76, v77
    v_cvt_pk_bf16_f32 v17, v92, v93
    v_lshlrev_b32 v18, 16, v16
    v_and_b32 v19, 0xffff0000, v16
    v_lshlrev_b32 v20, 16, v17
    v_and_b32 v21, 0xffff0000, v17
    v_max_f32 v18, 0, v18
    v_max_f32 v19, 0, v19
    v_mul_f32 v18, v18, v20
    v_mul_f32 v19, v19, v21
    v_cvt_pk_bf16_f32 v22, v18, v19
    v_cvt_pk_bf16_f32 v16, v78, v79
    v_cvt_pk_bf16_f32 v17, v94, v95
    v_lshlrev_b32 v18, 16, v16
    v_and_b32 v19, 0xffff0000, v16
    v_lshlrev_b32 v20, 16, v17
    v_and_b32 v21, 0xffff0000, v17
    v_max_f32 v18, 0, v18
    v_max_f32 v19, 0, v19
    v_mul_f32 v18, v18, v20
    v_mul_f32 v19, v19, v21
    v_cvt_pk_bf16_f32 v23, v18, v19
    buffer_store_dwordx2 v[22:23], v10, s[8:11], s28 offen offset:1536 sc1
    s_nop 1
    s_waitcnt vmcnt(0)
    s_barrier
    s_lshl_b32 s28, s22, 7
    s_add_u32 s28, s28, 32530432
    s_cmp_eq_u32 s20, 0
    s_cbranch_scc0 SF_39
    s_mov_b64 exec, 1
    buffer_atomic_add v7, v6, s[8:11], s28 offen
    s_mov_b64 exec, -1
SF_39:
    s_add_u32 s22, s22, s23
    s_cmp_lt_u32 s22, 64
    s_cbranch_scc1 W4_LOOP
    s_endpgm
ROLE_W5:
    s_load_dwordx2 s[16:17], s[0:1], 88
    s_waitcnt lgkmcnt(0)
    v_mov_b32 v6, 0
    s_mov_b32 s29, 32505856
    s_mov_b32 s34, 0
WF_40:
    buffer_load_dword v11, v6, s[8:11], s29 offen sc1
    s_add_u32 s34, s34, 1
    s_cmp_gt_u32 s34, 4194304
    s_cbranch_scc1 TK_ABORT
    s_waitcnt vmcnt(0)
    v_cmp_gt_u32 vcc, 16, v11
    s_cbranch_vccnz WF_40
    s_mul_i32 s24, s21, 392
    s_mul_i32 s25, s20, 14
    s_add_u32 s24, s24, s25
    s_lshl_b32 s24, s24, 10
    s_add_u32 s24, s24, 28311552
    s_add_u32 s26, s24, 0
    buffer_load_dwordx4 a[0:3], v3, s[8:11], s26 offen offset:0
    buffer_load_dwordx4 a[4:7], v3, s[8:11], s26 offen offset:1024
    buffer_load_dwordx4 a[8:11], v3, s[8:11], s26 offen offset:2048
    buffer_load_dwordx4 a[12:15], v3, s[8:11], s26 offen offset:3072
    s_add_u32 s26, s24, 4096
    buffer_load_dwordx4 a[16:19], v3, s[8:11], s26 offen offset:0
    buffer_load_dwordx4 a[20:23], v3, s[8:11], s26 offen offset:1024
    buffer_load_dwordx4 a[24:27], v3, s[8:11], s26 offen offset:2048
    buffer_load_dwordx4 a[28:31], v3, s[8:11], s26 offen offset:3072
    s_add_u32 s26, s24, 8192
    buffer_load_dwordx4 a[32:35], v3, s[8:11], s26 offen offset:0
    buffer_load_dwordx4 a[36:39], v3, s[8:11], s26 offen offset:1024
    buffer_load_dwordx4 a[40:43], v3, s[8:11], s26 offen offset:2048
    buffer_load_dwordx4 a[44:47], v3, s[8:11], s26 offen offset:3072
    s_add_u32 s26, s24, 12288
    buffer_load_dwordx4 a[48:51], v3, s[8:11], s26 offen offset:0
    buffer_load_dwordx4 a[52:55], v3, s[8:11], s26 offen offset:1024
    s_add_u32 s26, s24, 57344
    buffer_load_dwordx4 a[56:59], v3, s[8:11], s26 offen offset:0
    buffer_load_dwordx4 a[60:63], v3, s[8:11], s26 offen offset:1024
    buffer_load_dwordx4 a[64:67], v3, s[8:11], s26 offen offset:2048
    buffer_load_dwordx4 a[68:71], v3, s[8:11], s26 offen offset:3072
    s_add_u32 s26, s24, 61440
    buffer_load_dwordx4 a[72:75], v3, s[8:11], s26 offen offset:0
    buffer_load_dwordx4 a[76:79], v3, s[8:11], s26 offen offset:1024
    buffer_load_dwordx4 a[80:83], v3, s[8:11], s26 offen offset:2048
    buffer_load_dwordx4 a[84:87], v3, s[8:11], s26 offen offset:3072
    s_add_u32 s26, s24, 65536
    buffer_load_dwordx4 a[88:91], v3, s[8:11], s26 offen offset:0
    buffer_load_dwordx4 a[92:95], v3, s[8:11], s26 offen offset:1024
    buffer_load_dwordx4 a[96:99], v3, s[8:11], s26 offen offset:2048
    buffer_load_dwordx4 a[100:103], v3, s[8:11], s26 offen offset:3072
    s_add_u32 s26, s24, 69632
    buffer_load_dwordx4 a[104:107], v3, s[8:11], s26 offen offset:0
    buffer_load_dwordx4 a[108:111], v3, s[8:11], s26 offen offset:1024
    s_add_u32 s26, s24, 114688
    buffer_load_dwordx4 a[112:115], v3, s[8:11], s26 offen offset:0
    buffer_load_dwordx4 a[116:119], v3, s[8:11], s26 offen offset:1024
    buffer_load_dwordx4 a[120:123], v3, s[8:11], s26 offen offset:2048
    buffer_load_dwordx4 a[124:127], v3, s[8:11], s26 offen offset:3072
    s_add_u32 s26, s24, 118784
    buffer_load_dwordx4 a[128:131], v3, s[8:11], s26 offen offset:0
    buffer_load_dwordx4 a[132:135], v3, s[8:11], s26 offen offset:1024
    buffer_load_dwordx4 a[136:139], v3, s[8:11], s26 offen offset:2048
    buffer_load_dwordx4 a[140:143], v3, s[8:11], s26 offen offset:3072
    s_add_u32 s26, s24, 122880
    buffer_load_dwordx4 a[144:147], v3, s[8:11], s26 offen offset:0
    buffer_load_dwordx4 a[148:151], v3, s[8:11], s26 offen offset:1024
    buffer_load_dwordx4 a[152:155], v3, s[8:11], s26 offen offset:2048
    buffer_load_dwordx4 a[156:159], v3, s[8:11], s26 offen offset:3072
    s_add_u32 s26, s24, 126976
    buffer_load_dwordx4 a[160:163], v3, s[8:11], s26 offen offset:0
    buffer_load_dwordx4 a[164:167], v3, s[8:11], s26 offen offset:1024
    s_add_u32 s26, s24, 172032
    buffer_load_dwordx4 a[168:171], v3, s[8:11], s26 offen offset:0
    buffer_load_dwordx4 a[172:175], v3, s[8:11], s26 offen offset:1024
    buffer_load_dwordx4 a[176:179], v3, s[8:11], s26 offen offset:2048
    buffer_load_dwordx4 a[180:183], v3, s[8:11], s26 offen offset:3072
    s_add_u32 s26, s24, 176128
    buffer_load_dwordx4 a[184:187], v3, s[8:11], s26 offen offset:0
    buffer_load_dwordx4 a[188:191], v3, s[8:11], s26 offen offset:1024
    buffer_load_dwordx4 a[192:195], v3, s[8:11], s26 offen offset:2048
    buffer_load_dwordx4 a[196:199], v3, s[8:11], s26 offen offset:3072
    s_add_u32 s26, s24, 180224
    buffer_load_dwordx4 a[200:203], v3, s[8:11], s26 offen offset:0
    buffer_load_dwordx4 a[204:207], v3, s[8:11], s26 offen offset:1024
    buffer_load_dwordx4 a[208:211], v3, s[8:11], s26 offen offset:2048
    buffer_load_dwordx4 a[212:215], v3, s[8:11], s26 offen offset:3072
    s_add_u32 s26, s24, 184320
    buffer_load_dwordx4 a[216:219], v3, s[8:11], s26 offen offset:0
    buffer_load_dwordx4 a[220:223], v3, s[8:11], s26 offen offset:1024
    s_add_u32 s26, s24, 229376
    buffer_load_dwordx4 a[224:227], v3, s[8:11], s26 offen offset:0
    buffer_load_dwordx4 a[228:231], v3, s[8:11], s26 offen offset:1024
    buffer_load_dwordx4 a[232:235], v3, s[8:11], s26 offen offset:2048
    buffer_load_dwordx4 a[236:239], v3, s[8:11], s26 offen offset:3072
    s_add_u32 s26, s24, 233472
    buffer_load_dwordx4 a[240:243], v3, s[8:11], s26 offen offset:0
    buffer_load_dwordx4 a[244:247], v3, s[8:11], s26 offen offset:1024
    buffer_load_dwordx4 a[248:251], v3, s[8:11], s26 offen offset:2048
    buffer_load_dwordx4 a[252:255], v3, s[8:11], s26 offen offset:3072
    s_add_u32 s26, s24, 237568
    buffer_load_dwordx4 v[120:123], v3, s[8:11], s26 offen offset:0
    buffer_load_dwordx4 v[124:127], v3, s[8:11], s26 offen offset:1024
    buffer_load_dwordx4 v[128:131], v3, s[8:11], s26 offen offset:2048
    buffer_load_dwordx4 v[132:135], v3, s[8:11], s26 offen offset:3072
    s_add_u32 s26, s24, 241664
    buffer_load_dwordx4 v[136:139], v3, s[8:11], s26 offen offset:0
    buffer_load_dwordx4 v[140:143], v3, s[8:11], s26 offen offset:1024
    s_add_u32 s26, s24, 286720
    buffer_load_dwordx4 v[144:147], v3, s[8:11], s26 offen offset:0
    buffer_load_dwordx4 v[148:151], v3, s[8:11], s26 offen offset:1024
    buffer_load_dwordx4 v[152:155], v3, s[8:11], s26 offen offset:2048
    buffer_load_dwordx4 v[156:159], v3, s[8:11], s26 offen offset:3072
    s_add_u32 s26, s24, 290816
    buffer_load_dwordx4 v[160:163], v3, s[8:11], s26 offen offset:0
    buffer_load_dwordx4 v[164:167], v3, s[8:11], s26 offen offset:1024
    buffer_load_dwordx4 v[168:171], v3, s[8:11], s26 offen offset:2048
    buffer_load_dwordx4 v[172:175], v3, s[8:11], s26 offen offset:3072
    s_add_u32 s26, s24, 294912
    buffer_load_dwordx4 v[176:179], v3, s[8:11], s26 offen offset:0
    buffer_load_dwordx4 v[180:183], v3, s[8:11], s26 offen offset:1024
    buffer_load_dwordx4 v[184:187], v3, s[8:11], s26 offen offset:2048
    buffer_load_dwordx4 v[188:191], v3, s[8:11], s26 offen offset:3072
    s_add_u32 s26, s24, 299008
    buffer_load_dwordx4 v[192:195], v3, s[8:11], s26 offen offset:0
    buffer_load_dwordx4 v[196:199], v3, s[8:11], s26 offen offset:1024
    s_add_u32 s26, s24, 344064
    buffer_load_dwordx4 v[200:203], v3, s[8:11], s26 offen offset:0
    buffer_load_dwordx4 v[204:207], v3, s[8:11], s26 offen offset:1024
    buffer_load_dwordx4 v[208:211], v3, s[8:11], s26 offen offset:2048
    buffer_load_dwordx4 v[212:215], v3, s[8:11], s26 offen offset:3072
    s_add_u32 s26, s24, 348160
    buffer_load_dwordx4 v[216:219], v3, s[8:11], s26 offen offset:0
    buffer_load_dwordx4 v[220:223], v3, s[8:11], s26 offen offset:1024
    buffer_load_dwordx4 v[224:227], v3, s[8:11], s26 offen offset:2048
    buffer_load_dwordx4 v[228:231], v3, s[8:11], s26 offen offset:3072
    s_add_u32 s26, s24, 352256
    buffer_load_dwordx4 v[232:235], v3, s[8:11], s26 offen offset:0
    buffer_load_dwordx4 v[236:239], v3, s[8:11], s26 offen offset:1024
    buffer_load_dwordx4 v[240:243], v3, s[8:11], s26 offen offset:2048
    buffer_load_dwordx4 v[244:247], v3, s[8:11], s26 offen offset:3072
    s_add_u32 s26, s24, 356352
    buffer_load_dwordx4 v[248:251], v3, s[8:11], s26 offen offset:0
    buffer_load_dwordx4 v[252:255], v3, s[8:11], s26 offen offset:1024
    v_and_b32 v4, 15, v2
    v_lshrrev_b32 v5, 4, v2
    v_mov_b32 v6, 0
    v_mov_b32 v7, 1
    s_waitcnt lgkmcnt(0)
    s_mov_b32 s12, s16
    s_mov_b32 s13, s17
    s_mov_b32 s14, 1835008
    s_mov_b32 s15, 0x00020000
W5_LOOP:
    s_lshl_b32 s28, s22, 7
    s_add_u32 s29, s28, 32530432
    s_mov_b32 s34, 0
WF_41:
    buffer_load_dword v11, v6, s[8:11], s29 offen sc1
    s_add_u32 s34, s34, 1
    s_cmp_gt_u32 s34, 4194304
    s_cbranch_scc1 TK_ABORT
    s_waitcnt vmcnt(0)
    v_cmp_gt_u32 vcc, 14, v11
    s_cbranch_vccnz WF_41
    s_mul_i32 s28, s22, 114688
    s_mul_i32 s29, s20, 28672
    s_add_u32 s28, s28, s29
    s_add_u32 s28, s28, 77594624
    s_add_u32 s29, s28, 0
    buffer_load_dwordx4 v[68:71], v3, s[8:11], s29 offen offset:0 sc1
    s_add_u32 s29, s28, 0
    buffer_load_dwordx4 v[72:75], v3, s[8:11], s29 offen offset:1024 sc1
    s_add_u32 s29, s28, 0
    buffer_load_dwordx4 v[76:79], v3, s[8:11], s29 offen offset:2048 sc1
    s_add_u32 s29, s28, 0
    buffer_load_dwordx4 v[80:83], v3, s[8:11], s29 offen offset:3072 sc1
    s_add_u32 s29, s28, 4096
    buffer_load_dwordx4 v[84:87], v3, s[8:11], s29 offen offset:0 sc1
    s_add_u32 s29, s28, 4096
    buffer_load_dwordx4 v[88:91], v3, s[8:11], s29 offen offset:1024 sc1
    s_add_u32 s29, s28, 4096
    buffer_load_dwordx4 v[92:95], v3, s[8:11], s29 offen offset:2048 sc1
    s_add_u32 s29, s28, 4096
    buffer_load_dwordx4 v[96:99], v3, s[8:11], s29 offen offset:3072 sc1
    s_add_u32 s29, s28, 8192
    buffer_load_dwordx4 v[100:103], v3, s[8:11], s29 offen offset:0 sc1
    s_add_u32 s29, s28, 8192
    buffer_load_dwordx4 v[104:107], v3, s[8:11], s29 offen offset:1024 sc1
    s_add_u32 s29, s28, 8192
    buffer_load_dwordx4 v[108:111], v3, s[8:11], s29 offen offset:2048 sc1
    s_add_u32 s29, s28, 8192
    buffer_load_dwordx4 v[112:115], v3, s[8:11], s29 offen offset:3072 sc1
    s_waitcnt vmcnt(6)
    v_mfma_f32_16x16x32_bf16 v[12:15], a[0:3], v[68:71], 0
    v_mfma_f32_16x16x32_bf16 v[16:19], a[0:3], v[72:75], 0
    v_mfma_f32_16x16x32_bf16 v[20:23], a[56:59], v[68:71], 0
    v_mfma_f32_16x16x32_bf16 v[24:27], a[56:59], v[72:75], 0
    v_mfma_f32_16x16x32_bf16 v[28:31], a[112:115], v[68:71], 0
    v_mfma_f32_16x16x32_bf16 v[32:35], a[112:115], v[72:75], 0
    v_mfma_f32_16x16x32_bf16 v[36:39], a[168:171], v[68:71], 0
    v_mfma_f32_16x16x32_bf16 v[40:43], a[168:171], v[72:75], 0
    v_mfma_f32_16x16x32_bf16 v[44:47], a[224:227], v[68:71], 0
    v_mfma_f32_16x16x32_bf16 v[48:51], a[224:227], v[72:75], 0
    v_mfma_f32_16x16x32_bf16 v[52:55], v[144:147], v[68:71], 0
    v_mfma_f32_16x16x32_bf16 v[56:59], v[144:147], v[72:75], 0
    v_mfma_f32_16x16x32_bf16 v[60:63], v[200:203], v[68:71], 0
    v_mfma_f32_16x16x32_bf16 v[64:67], v[200:203], v[72:75], 0
    v_mfma_f32_16x16x32_bf16 v[12:15], a[4:7], v[76:79], v[12:15]
    v_mfma_f32_16x16x32_bf16 v[16:19], a[4:7], v[80:83], v[16:19]
    v_mfma_f32_16x16x32_bf16 v[20:23], a[60:63], v[76:79], v[20:23]
    v_mfma_f32_16x16x32_bf16 v[24:27], a[60:63], v[80:83], v[24:27]
    v_mfma_f32_16x16x32_bf16 v[28:31], a[116:119], v[76:79], v[28:31]
    v_mfma_f32_16x16x32_bf16 v[32:35], a[116:119], v[80:83], v[32:35]
    v_mfma_f32_16x16x32_bf16 v[36:39], a[172:175], v[76:79], v[36:39]
    v_mfma_f32_16x16x32_bf16 v[40:43], a[172:175], v[80:83], v[40:43]
    v_mfma_f32_16x16x32_bf16 v[44:47], a[228:231], v[76:79], v[44:47]
    v_mfma_f32_16x16x32_bf16 v[48:51], a[228:231], v[80:83], v[48:51]
    v_mfma_f32_16x16x32_bf16 v[52:55], v[148:151], v[76:79], v[52:55]
    v_mfma_f32_16x16x32_bf16 v[56:59], v[148:151], v[80:83], v[56:59]
    v_mfma_f32_16x16x32_bf16 v[60:63], v[204:207], v[76:79], v[60:63]
    v_mfma_f32_16x16x32_bf16 v[64:67], v[204:207], v[80:83], v[64:67]
    v_mfma_f32_16x16x32_bf16 v[12:15], a[8:11], v[84:87], v[12:15]
    v_mfma_f32_16x16x32_bf16 v[16:19], a[8:11], v[88:91], v[16:19]
    v_mfma_f32_16x16x32_bf16 v[20:23], a[64:67], v[84:87], v[20:23]
    v_mfma_f32_16x16x32_bf16 v[24:27], a[64:67], v[88:91], v[24:27]
    v_mfma_f32_16x16x32_bf16 v[28:31], a[120:123], v[84:87], v[28:31]
    v_mfma_f32_16x16x32_bf16 v[32:35], a[120:123], v[88:91], v[32:35]
    v_mfma_f32_16x16x32_bf16 v[36:39], a[176:179], v[84:87], v[36:39]
    v_mfma_f32_16x16x32_bf16 v[40:43], a[176:179], v[88:91], v[40:43]
    v_mfma_f32_16x16x32_bf16 v[44:47], a[232:235], v[84:87], v[44:47]
    v_mfma_f32_16x16x32_bf16 v[48:51], a[232:235], v[88:91], v[48:51]
    v_mfma_f32_16x16x32_bf16 v[52:55], v[152:155], v[84:87], v[52:55]
    v_mfma_f32_16x16x32_bf16 v[56:59], v[152:155], v[88:91], v[56:59]
    v_mfma_f32_16x16x32_bf16 v[60:63], v[208:211], v[84:87], v[60:63]
    v_mfma_f32_16x16x32_bf16 v[64:67], v[208:211], v[88:91], v[64:67]
    s_add_u32 s29, s28, 12288
    buffer_load_dwordx4 v[68:71], v3, s[8:11], s29 offen offset:0 sc1
    s_add_u32 s29, s28, 12288
    buffer_load_dwordx4 v[72:75], v3, s[8:11], s29 offen offset:1024 sc1
    s_add_u32 s29, s28, 12288
    buffer_load_dwordx4 v[76:79], v3, s[8:11], s29 offen offset:2048 sc1
    s_add_u32 s29, s28, 12288
    buffer_load_dwordx4 v[80:83], v3, s[8:11], s29 offen offset:3072 sc1
    s_add_u32 s29, s28, 16384
    buffer_load_dwordx4 v[84:87], v3, s[8:11], s29 offen offset:0 sc1
    s_add_u32 s29, s28, 16384
    buffer_load_dwordx4 v[88:91], v3, s[8:11], s29 offen offset:1024 sc1
    s_waitcnt vmcnt(6)
    v_mfma_f32_16x16x32_bf16 v[12:15], a[12:15], v[92:95], v[12:15]
    v_mfma_f32_16x16x32_bf16 v[16:19], a[12:15], v[96:99], v[16:19]
    v_mfma_f32_16x16x32_bf16 v[20:23], a[68:71], v[92:95], v[20:23]
    v_mfma_f32_16x16x32_bf16 v[24:27], a[68:71], v[96:99], v[24:27]
    v_mfma_f32_16x16x32_bf16 v[28:31], a[124:127], v[92:95], v[28:31]
    v_mfma_f32_16x16x32_bf16 v[32:35], a[124:127], v[96:99], v[32:35]
    v_mfma_f32_16x16x32_bf16 v[36:39], a[180:183], v[92:95], v[36:39]
    v_mfma_f32_16x16x32_bf16 v[40:43], a[180:183], v[96:99], v[40:43]
    v_mfma_f32_16x16x32_bf16 v[44:47], a[236:239], v[92:95], v[44:47]
    v_mfma_f32_16x16x32_bf16 v[48:51], a[236:239], v[96:99], v[48:51]
    v_mfma_f32_16x16x32_bf16 v[52:55], v[156:159], v[92:95], v[52:55]
    v_mfma_f32_16x16x32_bf16 v[56:59], v[156:159], v[96:99], v[56:59]
    v_mfma_f32_16x16x32_bf16 v[60:63], v[212:215], v[92:95], v[60:63]
    v_mfma_f32_16x16x32_bf16 v[64:67], v[212:215], v[96:99], v[64:67]
    v_mfma_f32_16x16x32_bf16 v[12:15], a[16:19], v[100:103], v[12:15]
    v_mfma_f32_16x16x32_bf16 v[16:19], a[16:19], v[104:107], v[16:19]
    v_mfma_f32_16x16x32_bf16 v[20:23], a[72:75], v[100:103], v[20:23]
    v_mfma_f32_16x16x32_bf16 v[24:27], a[72:75], v[104:107], v[24:27]
    v_mfma_f32_16x16x32_bf16 v[28:31], a[128:131], v[100:103], v[28:31]
    v_mfma_f32_16x16x32_bf16 v[32:35], a[128:131], v[104:107], v[32:35]
    v_mfma_f32_16x16x32_bf16 v[36:39], a[184:187], v[100:103], v[36:39]
    v_mfma_f32_16x16x32_bf16 v[40:43], a[184:187], v[104:107], v[40:43]
    v_mfma_f32_16x16x32_bf16 v[44:47], a[240:243], v[100:103], v[44:47]
    v_mfma_f32_16x16x32_bf16 v[48:51], a[240:243], v[104:107], v[48:51]
    v_mfma_f32_16x16x32_bf16 v[52:55], v[160:163], v[100:103], v[52:55]
    v_mfma_f32_16x16x32_bf16 v[56:59], v[160:163], v[104:107], v[56:59]
    v_mfma_f32_16x16x32_bf16 v[60:63], v[216:219], v[100:103], v[60:63]
    v_mfma_f32_16x16x32_bf16 v[64:67], v[216:219], v[104:107], v[64:67]
    v_mfma_f32_16x16x32_bf16 v[12:15], a[20:23], v[108:111], v[12:15]
    v_mfma_f32_16x16x32_bf16 v[16:19], a[20:23], v[112:115], v[16:19]
    v_mfma_f32_16x16x32_bf16 v[20:23], a[76:79], v[108:111], v[20:23]
    v_mfma_f32_16x16x32_bf16 v[24:27], a[76:79], v[112:115], v[24:27]
    v_mfma_f32_16x16x32_bf16 v[28:31], a[132:135], v[108:111], v[28:31]
    v_mfma_f32_16x16x32_bf16 v[32:35], a[132:135], v[112:115], v[32:35]
    v_mfma_f32_16x16x32_bf16 v[36:39], a[188:191], v[108:111], v[36:39]
    v_mfma_f32_16x16x32_bf16 v[40:43], a[188:191], v[112:115], v[40:43]
    v_mfma_f32_16x16x32_bf16 v[44:47], a[244:247], v[108:111], v[44:47]
    v_mfma_f32_16x16x32_bf16 v[48:51], a[244:247], v[112:115], v[48:51]
    v_mfma_f32_16x16x32_bf16 v[52:55], v[164:167], v[108:111], v[52:55]
    v_mfma_f32_16x16x32_bf16 v[56:59], v[164:167], v[112:115], v[56:59]
    v_mfma_f32_16x16x32_bf16 v[60:63], v[220:223], v[108:111], v[60:63]
    v_mfma_f32_16x16x32_bf16 v[64:67], v[220:223], v[112:115], v[64:67]
    s_add_u32 s29, s28, 16384
    buffer_load_dwordx4 v[92:95], v3, s[8:11], s29 offen offset:2048 sc1
    s_add_u32 s29, s28, 16384
    buffer_load_dwordx4 v[96:99], v3, s[8:11], s29 offen offset:3072 sc1
    s_add_u32 s29, s28, 20480
    buffer_load_dwordx4 v[100:103], v3, s[8:11], s29 offen offset:0 sc1
    s_add_u32 s29, s28, 20480
    buffer_load_dwordx4 v[104:107], v3, s[8:11], s29 offen offset:1024 sc1
    s_add_u32 s29, s28, 20480
    buffer_load_dwordx4 v[108:111], v3, s[8:11], s29 offen offset:2048 sc1
    s_add_u32 s29, s28, 20480
    buffer_load_dwordx4 v[112:115], v3, s[8:11], s29 offen offset:3072 sc1
    s_waitcnt vmcnt(6)
    v_mfma_f32_16x16x32_bf16 v[12:15], a[24:27], v[68:71], v[12:15]
    v_mfma_f32_16x16x32_bf16 v[16:19], a[24:27], v[72:75], v[16:19]
    v_mfma_f32_16x16x32_bf16 v[20:23], a[80:83], v[68:71], v[20:23]
    v_mfma_f32_16x16x32_bf16 v[24:27], a[80:83], v[72:75], v[24:27]
    v_mfma_f32_16x16x32_bf16 v[28:31], a[136:139], v[68:71], v[28:31]
    v_mfma_f32_16x16x32_bf16 v[32:35], a[136:139], v[72:75], v[32:35]
    v_mfma_f32_16x16x32_bf16 v[36:39], a[192:195], v[68:71], v[36:39]
    v_mfma_f32_16x16x32_bf16 v[40:43], a[192:195], v[72:75], v[40:43]
    v_mfma_f32_16x16x32_bf16 v[44:47], a[248:251], v[68:71], v[44:47]
    v_mfma_f32_16x16x32_bf16 v[48:51], a[248:251], v[72:75], v[48:51]
    v_mfma_f32_16x16x32_bf16 v[52:55], v[168:171], v[68:71], v[52:55]
    v_mfma_f32_16x16x32_bf16 v[56:59], v[168:171], v[72:75], v[56:59]
    v_mfma_f32_16x16x32_bf16 v[60:63], v[224:227], v[68:71], v[60:63]
    v_mfma_f32_16x16x32_bf16 v[64:67], v[224:227], v[72:75], v[64:67]
    v_mfma_f32_16x16x32_bf16 v[12:15], a[28:31], v[76:79], v[12:15]
    v_mfma_f32_16x16x32_bf16 v[16:19], a[28:31], v[80:83], v[16:19]
    v_mfma_f32_16x16x32_bf16 v[20:23], a[84:87], v[76:79], v[20:23]
    v_mfma_f32_16x16x32_bf16 v[24:27], a[84:87], v[80:83], v[24:27]
    v_mfma_f32_16x16x32_bf16 v[28:31], a[140:143], v[76:79], v[28:31]
    v_mfma_f32_16x16x32_bf16 v[32:35], a[140:143], v[80:83], v[32:35]
    v_mfma_f32_16x16x32_bf16 v[36:39], a[196:199], v[76:79], v[36:39]
    v_mfma_f32_16x16x32_bf16 v[40:43], a[196:199], v[80:83], v[40:43]
    v_mfma_f32_16x16x32_bf16 v[44:47], a[252:255], v[76:79], v[44:47]
    v_mfma_f32_16x16x32_bf16 v[48:51], a[252:255], v[80:83], v[48:51]
    v_mfma_f32_16x16x32_bf16 v[52:55], v[172:175], v[76:79], v[52:55]
    v_mfma_f32_16x16x32_bf16 v[56:59], v[172:175], v[80:83], v[56:59]
    v_mfma_f32_16x16x32_bf16 v[60:63], v[228:231], v[76:79], v[60:63]
    v_mfma_f32_16x16x32_bf16 v[64:67], v[228:231], v[80:83], v[64:67]
    v_mfma_f32_16x16x32_bf16 v[12:15], a[32:35], v[84:87], v[12:15]
    v_mfma_f32_16x16x32_bf16 v[16:19], a[32:35], v[88:91], v[16:19]
    v_mfma_f32_16x16x32_bf16 v[20:23], a[88:91], v[84:87], v[20:23]
    v_mfma_f32_16x16x32_bf16 v[24:27], a[88:91], v[88:91], v[24:27]
    v_mfma_f32_16x16x32_bf16 v[28:31], a[144:147], v[84:87], v[28:31]
    v_mfma_f32_16x16x32_bf16 v[32:35], a[144:147], v[88:91], v[32:35]
    v_mfma_f32_16x16x32_bf16 v[36:39], a[200:203], v[84:87], v[36:39]
    v_mfma_f32_16x16x32_bf16 v[40:43], a[200:203], v[88:91], v[40:43]
    v_mfma_f32_16x16x32_bf16 v[44:47], v[120:123], v[84:87], v[44:47]
    v_mfma_f32_16x16x32_bf16 v[48:51], v[120:123], v[88:91], v[48:51]
    v_mfma_f32_16x16x32_bf16 v[52:55], v[176:179], v[84:87], v[52:55]
    v_mfma_f32_16x16x32_bf16 v[56:59], v[176:179], v[88:91], v[56:59]
    v_mfma_f32_16x16x32_bf16 v[60:63], v[232:235], v[84:87], v[60:63]
    v_mfma_f32_16x16x32_bf16 v[64:67], v[232:235], v[88:91], v[64:67]
    s_add_u32 s29, s28, 24576
    buffer_load_dwordx4 v[68:71], v3, s[8:11], s29 offen offset:0 sc1
    s_add_u32 s29, s28, 24576
    buffer_load_dwordx4 v[72:75], v3, s[8:11], s29 offen offset:1024 sc1
    s_add_u32 s29, s28, 24576
    buffer_load_dwordx4 v[76:79], v3, s[8:11], s29 offen offset:2048 sc1
    s_add_u32 s29, s28, 24576
    buffer_load_dwordx4 v[80:83], v3, s[8:11], s29 offen offset:3072 sc1
    s_waitcnt vmcnt(4)
    v_mfma_f32_16x16x32_bf16 v[12:15], a[36:39], v[92:95], v[12:15]
    v_mfma_f32_16x16x32_bf16 v[16:19], a[36:39], v[96:99], v[16:19]
    v_mfma_f32_16x16x32_bf16 v[20:23], a[92:95], v[92:95], v[20:23]
    v_mfma_f32_16x16x32_bf16 v[24:27], a[92:95], v[96:99], v[24:27]
    v_mfma_f32_16x16x32_bf16 v[28:31], a[148:151], v[92:95], v[28:31]
    v_mfma_f32_16x16x32_bf16 v[32:35], a[148:151], v[96:99], v[32:35]
    v_mfma_f32_16x16x32_bf16 v[36:39], a[204:207], v[92:95], v[36:39]
    v_mfma_f32_16x16x32_bf16 v[40:43], a[204:207], v[96:99], v[40:43]
    v_mfma_f32_16x16x32_bf16 v[44:47], v[124:127], v[92:95], v[44:47]
    v_mfma_f32_16x16x32_bf16 v[48:51], v[124:127], v[96:99], v[48:51]
    v_mfma_f32_16x16x32_bf16 v[52:55], v[180:183], v[92:95], v[52:55]
    v_mfma_f32_16x16x32_bf16 v[56:59], v[180:183], v[96:99], v[56:59]
    v_mfma_f32_16x16x32_bf16 v[60:63], v[236:239], v[92:95], v[60:63]
    v_mfma_f32_16x16x32_bf16 v[64:67], v[236:239], v[96:99], v[64:67]
    v_mfma_f32_16x16x32_bf16 v[12:15], a[40:43], v[100:103], v[12:15]
    v_mfma_f32_16x16x32_bf16 v[16:19], a[40:43], v[104:107], v[16:19]
    v_mfma_f32_16x16x32_bf16 v[20:23], a[96:99], v[100:103], v[20:23]
    v_mfma_f32_16x16x32_bf16 v[24:27], a[96:99], v[104:107], v[24:27]
    v_mfma_f32_16x16x32_bf16 v[28:31], a[152:155], v[100:103], v[28:31]
    v_mfma_f32_16x16x32_bf16 v[32:35], a[152:155], v[104:107], v[32:35]
    v_mfma_f32_16x16x32_bf16 v[36:39], a[208:211], v[100:103], v[36:39]
    v_mfma_f32_16x16x32_bf16 v[40:43], a[208:211], v[104:107], v[40:43]
    v_mfma_f32_16x16x32_bf16 v[44:47], v[128:131], v[100:103], v[44:47]
    v_mfma_f32_16x16x32_bf16 v[48:51], v[128:131], v[104:107], v[48:51]
    v_mfma_f32_16x16x32_bf16 v[52:55], v[184:187], v[100:103], v[52:55]
    v_mfma_f32_16x16x32_bf16 v[56:59], v[184:187], v[104:107], v[56:59]
    v_mfma_f32_16x16x32_bf16 v[60:63], v[240:243], v[100:103], v[60:63]
    v_mfma_f32_16x16x32_bf16 v[64:67], v[240:243], v[104:107], v[64:67]
    v_mfma_f32_16x16x32_bf16 v[12:15], a[44:47], v[108:111], v[12:15]
    v_mfma_f32_16x16x32_bf16 v[16:19], a[44:47], v[112:115], v[16:19]
    v_mfma_f32_16x16x32_bf16 v[20:23], a[100:103], v[108:111], v[20:23]
    v_mfma_f32_16x16x32_bf16 v[24:27], a[100:103], v[112:115], v[24:27]
    v_mfma_f32_16x16x32_bf16 v[28:31], a[156:159], v[108:111], v[28:31]
    v_mfma_f32_16x16x32_bf16 v[32:35], a[156:159], v[112:115], v[32:35]
    v_mfma_f32_16x16x32_bf16 v[36:39], a[212:215], v[108:111], v[36:39]
    v_mfma_f32_16x16x32_bf16 v[40:43], a[212:215], v[112:115], v[40:43]
    v_mfma_f32_16x16x32_bf16 v[44:47], v[132:135], v[108:111], v[44:47]
    v_mfma_f32_16x16x32_bf16 v[48:51], v[132:135], v[112:115], v[48:51]
    v_mfma_f32_16x16x32_bf16 v[52:55], v[188:191], v[108:111], v[52:55]
    v_mfma_f32_16x16x32_bf16 v[56:59], v[188:191], v[112:115], v[56:59]
    v_mfma_f32_16x16x32_bf16 v[60:63], v[244:247], v[108:111], v[60:63]
    v_mfma_f32_16x16x32_bf16 v[64:67], v[244:247], v[112:115], v[64:67]
    s_waitcnt vmcnt(0)
    v_mfma_f32_16x16x32_bf16 v[12:15], a[48:51], v[68:71], v[12:15]
    v_mfma_f32_16x16x32_bf16 v[16:19], a[48:51], v[72:75], v[16:19]
    v_mfma_f32_16x16x32_bf16 v[20:23], a[104:107], v[68:71], v[20:23]
    v_mfma_f32_16x16x32_bf16 v[24:27], a[104:107], v[72:75], v[24:27]
    v_mfma_f32_16x16x32_bf16 v[28:31], a[160:163], v[68:71], v[28:31]
    v_mfma_f32_16x16x32_bf16 v[32:35], a[160:163], v[72:75], v[32:35]
    v_mfma_f32_16x16x32_bf16 v[36:39], a[216:219], v[68:71], v[36:39]
    v_mfma_f32_16x16x32_bf16 v[40:43], a[216:219], v[72:75], v[40:43]
    v_mfma_f32_16x16x32_bf16 v[44:47], v[136:139], v[68:71], v[44:47]
    v_mfma_f32_16x16x32_bf16 v[48:51], v[136:139], v[72:75], v[48:51]
    v_mfma_f32_16x16x32_bf16 v[52:55], v[192:195], v[68:71], v[52:55]
    v_mfma_f32_16x16x32_bf16 v[56:59], v[192:195], v[72:75], v[56:59]
    v_mfma_f32_16x16x32_bf16 v[60:63], v[248:251], v[68:71], v[60:63]
    v_mfma_f32_16x16x32_bf16 v[64:67], v[248:251], v[72:75], v[64:67]
    v_mfma_f32_16x16x32_bf16 v[12:15], a[52:55], v[76:79], v[12:15]
    v_mfma_f32_16x16x32_bf16 v[16:19], a[52:55], v[80:83], v[16:19]
    v_mfma_f32_16x16x32_bf16 v[20:23], a[108:111], v[76:79], v[20:23]
    v_mfma_f32_16x16x32_bf16 v[24:27], a[108:111], v[80:83], v[24:27]
    v_mfma_f32_16x16x32_bf16 v[28:31], a[164:167], v[76:79], v[28:31]
    v_mfma_f32_16x16x32_bf16 v[32:35], a[164:167], v[80:83], v[32:35]
    v_mfma_f32_16x16x32_bf16 v[36:39], a[220:223], v[76:79], v[36:39]
    v_mfma_f32_16x16x32_bf16 v[40:43], a[220:223], v[80:83], v[40:43]
    v_mfma_f32_16x16x32_bf16 v[44:47], v[140:143], v[76:79], v[44:47]
    v_mfma_f32_16x16x32_bf16 v[48:51], v[140:143], v[80:83], v[48:51]
    v_mfma_f32_16x16x32_bf16 v[52:55], v[196:199], v[76:79], v[52:55]
    v_mfma_f32_16x16x32_bf16 v[56:59], v[196:199], v[80:83], v[56:59]
    v_mfma_f32_16x16x32_bf16 v[60:63], v[252:255], v[76:79], v[60:63]
    v_mfma_f32_16x16x32_bf16 v[64:67], v[252:255], v[80:83], v[64:67]
    s_nop 7
    s_nop 1
    v_mul_u32_u24 v9, 896, v4
    v_lshl_add_u32 v9, v5, 3, v9
    s_add_u32 s28, s20, 0
    s_min_u32 s28, s28, 13
    s_lshr_b32 s29, s28, 1
    s_mul_i32 s30, s21, 7
    s_add_u32 s29, s29, s30
    s_lshl_b32 s29, s29, 5
    s_and_b32 s28, s28, 1
    s_mul_i32 s28, s28, 14336
    s_add_u32 s29, s29, s28
    s_mul_i32 s28, s22, 28672
    s_add_u32 s36, s29, s28
    s_add_u32 s30, s36, 75497472
    buffer_load_dwordx2 v[80:81], v9, s[8:11], s30 offen sc1
    s_add_u32 s28, s20, 4
    s_min_u32 s28, s28, 13
    s_lshr_b32 s29, s28, 1
    s_mul_i32 s30, s21, 7
    s_add_u32 s29, s29, s30
    s_lshl_b32 s29, s29, 5
    s_and_b32 s28, s28, 1
    s_mul_i32 s28, s28, 14336
    s_add_u32 s29, s29, s28
    s_mul_i32 s28, s22, 28672
    s_add_u32 s37, s29, s28
    s_add_u32 s30, s37, 75497472
    buffer_load_dwordx2 v[82:83], v9, s[8:11], s30 offen sc1
    s_add_u32 s28, s20, 8
    s_min_u32 s28, s28, 13
    s_lshr_b32 s29, s28, 1
    s_mul_i32 s30, s21, 7
    s_add_u32 s29, s29, s30
    s_lshl_b32 s29, s29, 5
    s_and_b32 s28, s28, 1
    s_mul_i32 s28, s28, 14336
    s_add_u32 s29, s29, s28
    s_mul_i32 s28, s22, 28672
    s_add_u32 s38, s29, s28
    s_add_u32 s30, s38, 75497472
    buffer_load_dwordx2 v[84:85], v9, s[8:11], s30 offen sc1
    s_add_u32 s28, s20, 12
    s_min_u32 s28, s28, 13
    s_lshr_b32 s29, s28, 1
    s_mul_i32 s30, s21, 7
    s_add_u32 s29, s29, s30
    s_lshl_b32 s29, s29, 5
    s_and_b32 s28, s28, 1
    s_mul_i32 s28, s28, 14336
    s_add_u32 s29, s29, s28
    s_mul_i32 s28, s22, 28672
    s_add_u32 s39, s29, s28
    s_add_u32 s30, s39, 75497472
    buffer_load_dwordx2 v[86:87], v9, s[8:11], s30 offen sc1
    s_mul_i32 s28, s20, 14336
    v_add_u32 v8, s28, v3
    ds_write_b128 v8, v[12:15] offset:0
    ds_write_b128 v8, v[16:19] offset:1024
    ds_write_b128 v8, v[20:23] offset:2048
    ds_write_b128 v8, v[24:27] offset:3072
    ds_write_b128 v8, v[28:31] offset:4096
    ds_write_b128 v8, v[32:35] offset:5120
    ds_write_b128 v8, v[36:39] offset:6144
    ds_write_b128 v8, v[40:43] offset:7168
    ds_write_b128 v8, v[44:47] offset:8192
    ds_write_b128 v8, v[48:51] offset:9216
    ds_write_b128 v8, v[52:55] offset:10240
    ds_write_b128 v8, v[56:59] offset:11264
    ds_write_b128 v8, v[60:63] offset:12288
    ds_write_b128 v8, v[64:67] offset:13312
    s_waitcnt lgkmcnt(0)
    s_barrier
    v_lshlrev_b32 v8, 4, v0
    ds_read_b128 v[12:15], v8 offset:0
    ds_read_b128 v[16:19], v8 offset:14336
    ds_read_b128 v[20:23], v8 offset:28672
    ds_read_b128 v[24:27], v8 offset:43008
    ds_read_b128 v[28:31], v8 offset:4096
    ds_read_b128 v[32:35], v8 offset:18432
    ds_read_b128 v[36:39], v8 offset:32768
    ds_read_b128 v[40:43], v8 offset:47104
    ds_read_b128 v[44:47], v8 offset:8192
    ds_read_b128 v[48:51], v8 offset:22528
    ds_read_b128 v[52:55], v8 offset:36864
    ds_read_b128 v[56:59], v8 offset:51200
    ds_read_b128 v[60:63], v8 offset:12288
    ds_read_b128 v[64:67], v8 offset:26624
    ds_read_b128 v[68:71], v8 offset:40960
    ds_read_b128 v[72:75], v8 offset:55296
    s_waitcnt vmcnt(0)
    s_waitcnt lgkmcnt(12)
    v_add_f32 v12, v12, v16
    v_add_f32 v20, v20, v24
    v_add_f32 v12, v12, v20
    v_add_f32 v13, v13, v17
    v_add_f32 v21, v21, v25
    v_add_f32 v13, v13, v21
    v_add_f32 v14, v14, v18
    v_add_f32 v22, v22, v26
    v_add_f32 v14, v14, v22
    v_add_f32 v15, v15, v19
    v_add_f32 v23, v23, v27
    v_add_f32 v15, v15, v23
    v_cvt_pk_bf16_f32 v16, v12, v13
    v_cvt_pk_bf16_f32 v17, v14, v15
    v_lshlrev_b32 v20, 16, v16
    v_and_b32 v21, 0xffff0000, v16
    v_lshlrev_b32 v22, 16, v80
    v_and_b32 v23, 0xffff0000, v80
    v_add_f32 v20, v20, v22
    v_add_f32 v21, v21, v23
    v_cvt_pk_bf16_f32 v18, v20, v21
    v_lshlrev_b32 v20, 16, v17
    v_and_b32 v21, 0xffff0000, v17
    v_lshlrev_b32 v22, 16, v81
    v_and_b32 v23, 0xffff0000, v81
    v_add_f32 v20, v20, v22
    v_add_f32 v21, v21, v23
    v_cvt_pk_bf16_f32 v19, v20, v21
    buffer_store_dwordx2 v[18:19], v9, s[12:15], s36 offen
    s_waitcnt lgkmcnt(8)
    v_add_f32 v28, v28, v32
    v_add_f32 v36, v36, v40
    v_add_f32 v28, v28, v36
    v_add_f32 v29, v29, v33
    v_add_f32 v37, v37, v41
    v_add_f32 v29, v29, v37
    v_add_f32 v30, v30, v34
    v_add_f32 v38, v38, v42
    v_add_f32 v30, v30, v38
    v_add_f32 v31, v31, v35
    v_add_f32 v39, v39, v43
    v_add_f32 v31, v31, v39
    v_cvt_pk_bf16_f32 v32, v28, v29
    v_cvt_pk_bf16_f32 v33, v30, v31
    v_lshlrev_b32 v36, 16, v32
    v_and_b32 v37, 0xffff0000, v32
    v_lshlrev_b32 v38, 16, v82
    v_and_b32 v39, 0xffff0000, v82
    v_add_f32 v36, v36, v38
    v_add_f32 v37, v37, v39
    v_cvt_pk_bf16_f32 v34, v36, v37
    v_lshlrev_b32 v36, 16, v33
    v_and_b32 v37, 0xffff0000, v33
    v_lshlrev_b32 v38, 16, v83
    v_and_b32 v39, 0xffff0000, v83
    v_add_f32 v36, v36, v38
    v_add_f32 v37, v37, v39
    v_cvt_pk_bf16_f32 v35, v36, v37
    buffer_store_dwordx2 v[34:35], v9, s[12:15], s37 offen
    s_waitcnt lgkmcnt(4)
    v_add_f32 v44, v44, v48
    v_add_f32 v52, v52, v56
    v_add_f32 v44, v44, v52
    v_add_f32 v45, v45, v49
    v_add_f32 v53, v53, v57
    v_add_f32 v45, v45, v53
    v_add_f32 v46, v46, v50
    v_add_f32 v54, v54, v58
    v_add_f32 v46, v46, v54
    v_add_f32 v47, v47, v51
    v_add_f32 v55, v55, v59
    v_add_f32 v47, v47, v55
    v_cvt_pk_bf16_f32 v48, v44, v45
    v_cvt_pk_bf16_f32 v49, v46, v47
    v_lshlrev_b32 v52, 16, v48
    v_and_b32 v53, 0xffff0000, v48
    v_lshlrev_b32 v54, 16, v84
    v_and_b32 v55, 0xffff0000, v84
    v_add_f32 v52, v52, v54
    v_add_f32 v53, v53, v55
    v_cvt_pk_bf16_f32 v50, v52, v53
    v_lshlrev_b32 v52, 16, v49
    v_and_b32 v53, 0xffff0000, v49
    v_lshlrev_b32 v54, 16, v85
    v_and_b32 v55, 0xffff0000, v85
    v_add_f32 v52, v52, v54
    v_add_f32 v53, v53, v55
    v_cvt_pk_bf16_f32 v51, v52, v53
    buffer_store_dwordx2 v[50:51], v9, s[12:15], s38 offen
    s_cmp_lt_u32 s20, 2
    s_cbranch_scc0 W5_FIN
    s_waitcnt lgkmcnt(0)
    v_add_f32 v60, v60, v64
    v_add_f32 v68, v68, v72
    v_add_f32 v60, v60, v68
    v_add_f32 v61, v61, v65
    v_add_f32 v69, v69, v73
    v_add_f32 v61, v61, v69
    v_add_f32 v62, v62, v66
    v_add_f32 v70, v70, v74
    v_add_f32 v62, v62, v70
    v_add_f32 v63, v63, v67
    v_add_f32 v71, v71, v75
    v_add_f32 v63, v63, v71
    v_cvt_pk_bf16_f32 v64, v60, v61
    v_cvt_pk_bf16_f32 v65, v62, v63
    v_lshlrev_b32 v68, 16, v64
    v_and_b32 v69, 0xffff0000, v64
    v_lshlrev_b32 v70, 16, v86
    v_and_b32 v71, 0xffff0000, v86
    v_add_f32 v68, v68, v70
    v_add_f32 v69, v69, v71
    v_cvt_pk_bf16_f32 v66, v68, v69
    v_lshlrev_b32 v68, 16, v65
    v_and_b32 v69, 0xffff0000, v65
    v_lshlrev_b32 v70, 16, v87
    v_and_b32 v71, 0xffff0000, v87
    v_add_f32 v68, v68, v70
    v_add_f32 v69, v69, v71
    v_cvt_pk_bf16_f32 v67, v68, v69
    buffer_store_dwordx2 v[66:67], v9, s[12:15], s39 offen
W5_FIN:
    s_barrier
    s_add_u32 s22, s22, s23
    s_cmp_lt_u32 s22, 64
    s_cbranch_scc1 W5_LOOP
    s_endpgm
TK_ABORT:
    s_endpgm
.section .rodata,"a"
.p2align 6
.amdhsa_kernel prep_kernel
  .amdhsa_next_free_vgpr 128
  .amdhsa_next_free_sgpr 48
  .amdhsa_accum_offset 128
  .amdhsa_group_segment_fixed_size 0
  .amdhsa_kernarg_size 112
  .amdhsa_user_sgpr_count 2
  .amdhsa_user_sgpr_kernarg_segment_ptr 1
  .amdhsa_system_sgpr_workgroup_id_x 1
.end_amdhsa_kernel
.p2align 6
.amdhsa_kernel main_kernel
  .amdhsa_next_free_vgpr 512
  .amdhsa_next_free_sgpr 96
  .amdhsa_accum_offset 256
  .amdhsa_group_segment_fixed_size 0
  .amdhsa_kernarg_size 112
  .amdhsa_user_sgpr_count 2
  .amdhsa_user_sgpr_kernarg_segment_ptr 1
  .amdhsa_system_sgpr_workgroup_id_x 1
.end_amdhsa_kernel
```
